```python
import torch

def _softmax(x, axis=-1):
    return torch.softmax(x, dim=axis)
def _gelu(x):
    return torch.nn.functional.gelu(x, approximate="tanh")
def _silu(x):
    return torch.nn.functional.silu(x)
def _sigmoid(x):
    return torch.sigmoid(x)
def _layernorm(x, axis=-1, eps=1e-5):
    m = x.mean(dim=axis, keepdim=True)
    v = x.var(dim=axis, keepdim=True, unbiased=False)
    return (x - m) / torch.sqrt(v + eps)
def _scatter_add(tgt, idx, src, axis=0):
    return tgt.clone().index_add_(axis, idx, src)
def _segment_sum(src, seg, n):
    out = torch.zeros((n,) + src.shape[1:], dtype=src.dtype)
    return out.index_add_(0, seg, src)
def _pad(x, pw):
    flat = tuple(v for pair in reversed(pw) for v in pair)
    return torch.nn.functional.pad(x, flat)

kernel_name = 'standalone__standard_2d_1d_3d_conv__vision'

def setup_inputs():

    _w = (lambda a: (lambda t: t.to(torch.bfloat16) if t.is_floating_point() else t)(torch.as_tensor(a)))
    H = W = 384
    C = 96
    K = 3
    return {
        "x": _w((lambda *s: torch.randn(*s, dtype=torch.bfloat16) * 0.05)(1, H, W, C)),
        "w": _w((lambda *s: torch.randn(*s, dtype=torch.bfloat16) * 0.05)(K, K, C, C)),
        "b": _w((lambda *s: torch.randn(*s, dtype=torch.bfloat16) * 0.05)(C)),
    }

def reference(x, w, b):
    B, H, W, Cin = x.shape
    K = w.shape[0]
    pl = (K - 1) // 2
    pr = K // 2
    xp = _pad(x, ((0, 0), (pl, pr), (pl, pr), (0, 0)))
    out = sum(
        torch.einsum('bhwc,cd->bhwd', xp[:, i:i+H, j:j+W, :], w[i, j])
        for i in range(K) for j in range(K)
    )
    return out + b[None, None, None, :]
```

```asm
; @launch grid=(256,1,1) block=(256,1,1) lds=163840
.amdgcn_target "amdgcn-amd-amdhsa--gfx950"
.text
.globl standalone__standard_2d_1d_3d_conv__vision_kernel
.p2align 12
.p2align 8
.type standalone__standard_2d_1d_3d_conv__vision_kernel,@function
standalone__standard_2d_1d_3d_conv__vision_kernel:
L_start:
    s_load_dwordx8 s[4:11], s[0:1], 0
    s_cmp_ge_u32 s2, 256
    s_cbranch_scc1 L_end
    v_lshrrev_b32 v244, 6, v0
    v_and_b32 v0, 63, v0
    v_readfirstlane_b32 s28, v244
    s_mov_b32 s18, 165888
    s_mov_b32 s19, 0x20000
    s_and_b32 s29, s28, 1
    s_lshr_b32 s30, s28, 1
    s_mul_i32 s34, s28, 4608
    v_lshlrev_b32 v19, 4, v0
    s_lshl_b32 s37, s29, 5
    v_add_u32 v244, s34, v19
    v_xor_b32 v9, s37, v244
    v_and_b32 v245, 32, v0
    v_xor_b32 v11, 32, v9
    v_xor_b32 v10, v245, v9
    s_and_b32 s41, s2, 7
    s_lshr_b32 s42, s2, 3
    s_mul_i32 s32, s42, 884736
    s_mul_i32 s36, s41, 9216
    s_add_u32 s35, s32, s36
    s_sub_u32 s32, s35, 73728
    s_mul_i32 s36, s30, 442368
    s_add_u32 s31, s32, s36
    s_add_u32 s35, s35, s36
    s_mul_i32 s40, s30, 9600
    s_lshl_b32 s36, s29, 10
    s_add_u32 s33, s40, s36
    s_mov_b32 s14, 28311744
    s_mov_b32 s15, 0x20000
    s_lshl_b32 s36, s29, 6
    s_movk_i32 s38, 1366
    v_add_u32 v244, s36, v0
    v_add_u32 v245, 0, v244
    v_mul_u32_u24 v246, s38, v245
    v_lshrrev_b32 v246, 15, v246
    v_and_b32 v246, 2, v246
    v_xor_b32 v246, v246, v244
    v_lshlrev_b32 v4, 4, v246
    s_or_b32 s36, s41, s29
    s_cmp_eq_u32 s36, 0
    s_cselect_b32 s36, 12, 0
    v_cmp_gt_u32 vcc, s36, v0
    v_mov_b32 v250, 1073741824
    v_add_u32 v245, 128, v244
    v_mul_u32_u24 v246, s38, v245
    v_lshrrev_b32 v246, 15, v246
    v_and_b32 v246, 2, v246
    v_xor_b32 v246, v246, v244
    v_lshlrev_b32 v5, 4, v246
    v_cndmask_b32 v4, v4, v250, vcc
    v_lshrrev_b32 v251, 4, v0
    s_mul_i32 s36, s29, 96
    v_lshlrev_b32 v247, 3, v251
    s_lshl_b32 s45, s28, 8
    s_add_u32 s45, s45, 153600
    s_add_u32 s36, s36, s45
    v_add_u32 v247, s36, v247
    v_lshlrev_b32 v243, 2, v0
    s_mov_b32 s22, 192
    s_mov_b32 s23, 0x20000
    s_lshl_b32 s36, s42, 2
    s_add_u32 s36, s36, s28
    s_mul_i32 s44, s36, 1408
    s_lshl_b32 s36, s36, 8
    v_lshlrev_b32 v248, 7, v0
    v_add_u32 v249, s36, v248
    s_lshl_b32 s36, s28, 12
    s_add_u32 s36, s36, 4096-256-(L_pc-L_start)
    v_cmp_gt_u32 vcc, 2, v0
    v_add_u32 v252, s36, v248
    s_nop 0
    v_cndmask_b32 v249, v252, v249, vcc
    v_min_u32 v249, L_end-L_pc, v249
    s_getpc_b64 s[48:49]
L_pc:
    s_mov_b64 exec, 15
    global_load_dword v147, v249, s[48:49]
    s_mov_b64 exec, -1
    s_waitcnt lgkmcnt(0)
    s_mov_b32 s20, s8
    s_mov_b32 s21, s9
    s_mov_b32 s16, s6
    s_mov_b32 s17, s7
    s_sub_u32 s12, s4, 192
    s_subb_u32 s13, s5, 0
    s_mov_b32 m0, s45
    s_nop 0
    buffer_load_dword v243, s[20:23], 0 offen lds
    s_mov_b32 s47, 0
    s_add_u32 m0, s34, 19200
    s_nop 0
    buffer_load_dwordx4 v9, s[16:19], s47 offen offset:0 lds
    buffer_load_dwordx4 v10, s[16:19], s47 offen offset:1024 lds
    buffer_load_dwordx4 v11, s[16:19], s47 offen offset:2048 lds
    buffer_load_dwordx4 v9, s[16:19], s47 offen offset:3072 lds
    buffer_load_dwordx4 v9, s[16:19], s47 offen offset:3584 lds
    v_add_u32 v245, 256, v244
    v_mul_u32_u24 v246, s38, v245
    v_lshrrev_b32 v246, 15, v246
    v_and_b32 v246, 2, v246
    v_xor_b32 v246, v246, v244
    v_lshlrev_b32 v246, 4, v246
    v_add_u32 v6, 4096, v246
    v_add_u32 v245, 384, v244
    v_mul_u32_u24 v246, s38, v245
    v_lshrrev_b32 v246, 15, v246
    v_and_b32 v246, 2, v246
    v_xor_b32 v246, v246, v244
    v_lshlrev_b32 v246, 4, v246
    v_add_u32 v7, 4096, v246
    v_add_u32 v245, 472, v244
    v_mul_u32_u24 v246, s38, v245
    v_lshrrev_b32 v246, 15, v246
    v_and_b32 v246, 2, v246
    v_xor_b32 v246, v246, v244
    v_lshlrev_b32 v246, 4, v246
    v_add_u32 v8, 4096, v246
    s_lshl_b32 s36, s29, 3
    s_or_b32 s36, s36, s41
    s_cmp_eq_u32 s36, 15
    s_cselect_b32 s36, 52, 64
    v_cmp_le_u32 vcc, s36, v0
    s_or_b32 s36, s42, s30
    s_cmp_eq_u32 s36, 0
    s_cselect_b32 s39, 1073741824, s31
    v_cndmask_b32 v8, v8, v250, vcc
    s_add_u32 s46, s31, 147456
    s_add_u32 m0, s33, 0
    s_nop 0
    buffer_load_dwordx4 v4, s[12:15], s46 offen offset:0 nt lds
    buffer_load_dwordx4 v5, s[12:15], s46 offen offset:2048 nt lds
    s_add_u32 m0, s33, 4096
    s_nop 0
    buffer_load_dwordx4 v6, s[12:15], s46 offen offset:0 nt lds
    buffer_load_dwordx4 v7, s[12:15], s46 offen offset:2048 nt lds
    buffer_load_dwordx4 v8, s[12:15], s46 offen offset:3456 nt lds
    s_mov_b64 exec, 0x7ff
    buffer_load_dword v146, v248, s[16:19], s44 offen
    s_mov_b64 exec, -1
    s_movk_i32 s37, 192
    v_bfe_u32 v252, v0, 2, 2
    v_lshl_add_u32 v252, v251, 3, v252
    v_mul_u32_u24 v252, s37, v252
    v_and_b32 v253, 1, v0
    v_lshl_add_u32 v252, v253, 3, v252
    v_bfe_u32 v253, v0, 1, 1
    s_mul_i32 s36, s29, 6
    v_add_u32 v253, s36, v253
    v_bfe_u32 v254, v0, 4, 1
    v_lshlrev_b32 v254, 1, v254
    v_add_u32 v255, 0, v253
    v_xor_b32 v255, v255, v254
    v_lshl_add_u32 v255, v255, 4, v252
    v_add_u32 v12, 19200, v255
    v_add_u32 v255, 2, v253
    v_xor_b32 v255, v255, v254
    v_lshl_add_u32 v255, v255, 4, v252
    v_add_u32 v13, 19200, v255
    s_movk_i32 s37, 192
    v_and_b32 v252, 15, v0
    v_mul_u32_u24 v252, 3, v252
    v_add_u32 v253, 0, v252
    v_lshrrev_b32 v254, 1, v253
    v_and_b32 v254, 2, v254
    v_xor_b32 v254, v254, v251
    v_lshlrev_b32 v254, 4, v254
    v_mad_u32_u24 v254, v253, s37, v254
    v_add_u32 v1, s40, v254
    v_add_u32 v253, 1, v252
    v_lshrrev_b32 v254, 1, v253
    v_and_b32 v254, 2, v254
    v_xor_b32 v254, v254, v251
    v_lshlrev_b32 v254, 4, v254
    v_mad_u32_u24 v254, v253, s37, v254
    v_add_u32 v2, s40, v254
    v_add_u32 v253, 2, v252
    v_lshrrev_b32 v254, 1, v253
    v_and_b32 v254, 2, v254
    v_xor_b32 v254, v254, v251
    v_lshlrev_b32 v254, 4, v254
    v_mad_u32_u24 v254, v253, s37, v254
    v_add_u32 v3, s40, v254
    v_add_u32 v253, 3, v252
    v_lshrrev_b32 v254, 1, v253
    v_and_b32 v254, 2, v254
    v_xor_b32 v254, v254, v251
    v_lshlrev_b32 v254, 4, v254
    v_mad_u32_u24 v254, v253, s37, v254
    v_add_u32 v16, s40, v254
    v_add_u32 v253, 4, v252
    v_lshrrev_b32 v254, 1, v253
    v_and_b32 v254, 2, v254
    v_xor_b32 v254, v254, v251
    v_lshlrev_b32 v254, 4, v254
    v_mad_u32_u24 v254, v253, s37, v254
    v_add_u32 v17, s40, v254
    s_mov_b32 s24, s10
    s_mov_b32 s25, s11
    s_mov_b32 s26, 28311552
    s_mov_b32 s27, 0x20000
    s_movk_i32 s37, 576
    v_and_b32 v252, 15, v0
    s_mul_i32 s38, s30, 9216
    v_mul_u32_u24 v253, s37, v252
    v_add_u32 v253, s38, v253
    v_bfe_u32 v254, v0, 4, 1
    v_lshl_add_u32 v253, v254, 3, v253
    v_bfe_u32 v254, v0, 1, 2
    s_mul_i32 s36, s29, 6
    v_lshrrev_b32 v252, 5, v0
    v_add_u32 v252, s36, v252
    v_add_u32 v255, 0, v252
    v_xor_b32 v255, v255, v254
    v_lshl_add_u32 v14, v255, 4, v253
    v_add_u32 v255, 2, v252
    v_xor_b32 v255, v255, v254
    v_lshl_add_u32 v15, v255, 4, v253
    s_mov_b32 s47, 55296
    s_add_u32 m0, s34, 112896
    s_nop 0
    buffer_load_dwordx4 v9, s[16:19], s47 offen offset:0 lds
    buffer_load_dwordx4 v10, s[16:19], s47 offen offset:1024 lds
    buffer_load_dwordx4 v11, s[16:19], s47 offen offset:2048 lds
    buffer_load_dwordx4 v9, s[16:19], s47 offen offset:3072 lds
    buffer_load_dwordx4 v9, s[16:19], s47 offen offset:3584 lds
    s_mov_b64 vcc, -1
    s_cmp_eq_u32 s28, 0
    s_cbranch_scc1 L_pad0
    s_cmp_eq_u32 s28, 1
    s_cbranch_scc1 L_pad1
    s_cmp_eq_u32 s28, 2
    s_cbranch_scc1 L_pad2
    s_cmp_eq_u32 s28, 3
    s_cbranch_scc1 L_pad3
L_padret:
    s_mov_b64 vcc, 0
    s_waitcnt vmcnt(11)
    s_barrier
    ds_read_b64_tr_b16 a[0:1], v12 offset:0
    ds_read_b64_tr_b16 a[2:3], v12 offset:768
    ds_read_b64_tr_b16 a[12:13], v12 offset:6144
    ds_read_b64_tr_b16 a[14:15], v12 offset:6912
    ds_read_b64_tr_b16 a[24:25], v12 offset:12288
    ds_read_b64_tr_b16 a[26:27], v12 offset:13056
    ds_read_b64_tr_b16 a[4:5], v13 offset:0
    ds_read_b64_tr_b16 a[6:7], v13 offset:768
    ds_read_b64_tr_b16 a[16:17], v13 offset:6144
    ds_read_b64_tr_b16 a[18:19], v13 offset:6912
    ds_read_b64_tr_b16 a[28:29], v13 offset:12288
    ds_read_b64_tr_b16 a[30:31], v13 offset:13056
    ds_read_b64_tr_b16 a[8:9], v12 offset:64
    ds_read_b64_tr_b16 a[10:11], v12 offset:832
    ds_read_b64_tr_b16 a[20:21], v12 offset:6208
    ds_read_b64_tr_b16 a[22:23], v12 offset:6976
    ds_read_b64_tr_b16 a[32:33], v12 offset:12352
    ds_read_b64_tr_b16 a[34:35], v12 offset:13120
    ds_read_b64 v[22:23], v247 offset:0
    ds_read_b64 v[26:27], v247 offset:32
    ds_read_b64 v[30:31], v247 offset:64
    s_waitcnt lgkmcnt(2)
    v_lshlrev_b32 v20, 16, v22
    v_and_b32 v21, 0xffff0000, v22
    v_lshlrev_b32 v22, 16, v23
    v_and_b32 v23, 0xffff0000, v23
    s_waitcnt lgkmcnt(1)
    v_lshlrev_b32 v24, 16, v26
    v_and_b32 v25, 0xffff0000, v26
    v_lshlrev_b32 v26, 16, v27
    v_and_b32 v27, 0xffff0000, v27
    s_waitcnt lgkmcnt(0)
    v_lshlrev_b32 v28, 16, v30
    v_and_b32 v29, 0xffff0000, v30
    v_lshlrev_b32 v30, 16, v31
    v_and_b32 v31, 0xffff0000, v31
    s_mov_b32 s47, 110592
    s_add_u32 m0, s34, 131328
    s_nop 0
    buffer_load_dwordx4 v9, s[16:19], s47 offen offset:0 lds
    buffer_load_dwordx4 v10, s[16:19], s47 offen offset:1024 lds
    buffer_load_dwordx4 v11, s[16:19], s47 offen offset:2048 lds
    buffer_load_dwordx4 v9, s[16:19], s47 offen offset:3072 lds
    buffer_load_dwordx4 v9, s[16:19], s47 offen offset:3584 lds
    s_waitcnt vmcnt(11)
    s_barrier
    ds_read_b128 v[32:35], v1 offset:0
    ds_read_b128 v[36:39], v1 offset:64
    ds_read_b128 v[40:43], v1 offset:128
    ds_read_b128 v[44:47], v2 offset:0
    s_mov_b32 s47, 18432
    s_add_u32 m0, s34, 57600
    s_waitcnt lgkmcnt(3)
    v_mfma_f32_16x16x32_bf16 v[220:223], a[0:3], v[32:35], v[20:23]
    buffer_load_dwordx4 v9, s[16:19], s47 offen offset:0 lds
    s_waitcnt lgkmcnt(2)
    v_mfma_f32_16x16x32_bf16 v[220:223], a[12:15], v[36:39], v[220:223]
    ds_read_b128 v[48:51], v2 offset:64
    s_waitcnt lgkmcnt(2)
    v_mfma_f32_16x16x32_bf16 v[220:223], a[24:27], v[40:43], v[220:223]
    ds_read_b128 v[52:55], v2 offset:128
    v_mfma_f32_16x16x32_bf16 v[224:227], a[4:7], v[32:35], v[24:27]
    buffer_load_dwordx4 v10, s[16:19], s47 offen offset:1024 lds
    v_mfma_f32_16x16x32_bf16 v[224:227], a[16:19], v[36:39], v[224:227]
    ds_read_b128 v[56:59], v3 offset:0
    v_mfma_f32_16x16x32_bf16 v[224:227], a[28:31], v[40:43], v[224:227]
    ds_read_b128 v[60:63], v3 offset:64
    v_mfma_f32_16x16x32_bf16 v[228:231], a[8:11], v[32:35], v[28:31]
    buffer_load_dwordx4 v11, s[16:19], s47 offen offset:2048 lds
    v_mfma_f32_16x16x32_bf16 v[228:231], a[20:23], v[36:39], v[228:231]
    ds_read_b128 v[64:67], v3 offset:128
    v_mfma_f32_16x16x32_bf16 v[228:231], a[32:35], v[40:43], v[228:231]
    s_waitcnt lgkmcnt(5)
    v_mfma_f32_16x16x32_bf16 v[232:235], a[0:3], v[44:47], v[20:23]
    buffer_load_dwordx4 v9, s[16:19], s47 offen offset:3072 lds
    s_waitcnt lgkmcnt(4)
    v_mfma_f32_16x16x32_bf16 v[232:235], a[12:15], v[48:51], v[232:235]
    s_waitcnt lgkmcnt(3)
    v_mfma_f32_16x16x32_bf16 v[232:235], a[24:27], v[52:55], v[232:235]
    v_mfma_f32_16x16x32_bf16 v[236:239], a[4:7], v[44:47], v[24:27]
    buffer_load_dwordx4 v9, s[16:19], s47 offen offset:3584 lds
    v_mfma_f32_16x16x32_bf16 v[236:239], a[16:19], v[48:51], v[236:239]
    v_mfma_f32_16x16x32_bf16 v[236:239], a[28:31], v[52:55], v[236:239]
    v_mfma_f32_16x16x32_bf16 v[240:243], a[8:11], v[44:47], v[28:31]
    v_mfma_f32_16x16x32_bf16 v[240:243], a[20:23], v[48:51], v[240:243]
    v_mfma_f32_16x16x32_bf16 v[240:243], a[32:35], v[52:55], v[240:243]
    s_waitcnt vmcnt(10)
    s_barrier
    v_add_u32 v12, 0x16e00, v12
    v_add_u32 v13, 0x16e00, v13
    s_waitcnt lgkmcnt(1)
    v_mfma_f32_16x16x32_bf16 v[244:247], a[0:3], v[56:59], v[20:23]
    ds_read_b64_tr_b16 a[36:37], v12 offset:0
    ds_read_b64_tr_b16 a[38:39], v12 offset:768
    v_mfma_f32_16x16x32_bf16 v[244:247], a[12:15], v[60:63], v[244:247]
    ds_read_b64_tr_b16 a[48:49], v12 offset:6144
    ds_read_b64_tr_b16 a[50:51], v12 offset:6912
    s_waitcnt lgkmcnt(4)
    v_mfma_f32_16x16x32_bf16 v[244:247], a[24:27], v[64:67], v[244:247]
    ds_read_b64_tr_b16 a[60:61], v12 offset:12288
    ds_read_b64_tr_b16 a[62:63], v12 offset:13056
    v_mfma_f32_16x16x32_bf16 v[248:251], a[4:7], v[56:59], v[24:27]
    ds_read_b64_tr_b16 a[40:41], v13 offset:0
    ds_read_b64_tr_b16 a[42:43], v13 offset:768
    v_mfma_f32_16x16x32_bf16 v[248:251], a[16:19], v[60:63], v[248:251]
    ds_read_b64_tr_b16 a[52:53], v13 offset:6144
    ds_read_b64_tr_b16 a[54:55], v13 offset:6912
    v_mfma_f32_16x16x32_bf16 v[248:251], a[28:31], v[64:67], v[248:251]
    ds_read_b64_tr_b16 a[64:65], v13 offset:12288
    ds_read_b64_tr_b16 a[66:67], v13 offset:13056
    v_mfma_f32_16x16x32_bf16 v[252:255], a[8:11], v[56:59], v[28:31]
    ds_read_b64_tr_b16 a[44:45], v12 offset:64
    ds_read_b64_tr_b16 a[46:47], v12 offset:832
    v_mfma_f32_16x16x32_bf16 v[252:255], a[20:23], v[60:63], v[252:255]
    ds_read_b64_tr_b16 a[56:57], v12 offset:6208
    ds_read_b64_tr_b16 a[58:59], v12 offset:6976
    v_mfma_f32_16x16x32_bf16 v[252:255], a[32:35], v[64:67], v[252:255]
    ds_read_b64_tr_b16 a[68:69], v12 offset:12352
    ds_read_b64_tr_b16 a[70:71], v12 offset:13120
    s_waitcnt lgkmcnt(14)
    v_mfma_f32_16x16x32_bf16 v[184:187], a[36:39], v[32:35], v[20:23]
    v_mfma_f32_16x16x32_bf16 v[184:187], a[48:51], v[36:39], v[184:187]
    s_waitcnt lgkmcnt(12)
    v_mfma_f32_16x16x32_bf16 v[184:187], a[60:63], v[40:43], v[184:187]
    s_mov_b32 s47, 73728
    s_add_u32 m0, s34, 76032
    s_waitcnt vmcnt(5)
    s_waitcnt lgkmcnt(10)
    v_mfma_f32_16x16x32_bf16 v[188:191], a[40:43], v[32:35], v[24:27]
    s_barrier
    s_waitcnt lgkmcnt(8)
    v_mfma_f32_16x16x32_bf16 v[188:191], a[52:55], v[36:39], v[188:191]
    buffer_load_dwordx4 v9, s[16:19], s47 offen offset:0 lds
    s_waitcnt lgkmcnt(6)
    v_mfma_f32_16x16x32_bf16 v[188:191], a[64:67], v[40:43], v[188:191]
    ds_read_b64_tr_b16 a[72:73], v12 offset:18432
    ds_read_b64_tr_b16 a[74:75], v12 offset:19200
    s_waitcnt lgkmcnt(6)
    v_mfma_f32_16x16x32_bf16 v[192:195], a[44:47], v[32:35], v[28:31]
    ds_read_b64_tr_b16 a[84:85], v12 offset:24576
    ds_read_b64_tr_b16 a[86:87], v12 offset:25344
    s_waitcnt lgkmcnt(6)
    v_mfma_f32_16x16x32_bf16 v[192:195], a[56:59], v[36:39], v[192:195]
    buffer_load_dwordx4 v10, s[16:19], s47 offen offset:1024 lds
    s_waitcnt lgkmcnt(4)
    v_mfma_f32_16x16x32_bf16 v[192:195], a[68:71], v[40:43], v[192:195]
    ds_read_b64_tr_b16 a[96:97], v12 offset:30720
    ds_read_b64_tr_b16 a[98:99], v12 offset:31488
    v_mfma_f32_16x16x32_bf16 v[196:199], a[36:39], v[44:47], v[20:23]
    ds_read_b64_tr_b16 a[76:77], v13 offset:18432
    ds_read_b64_tr_b16 a[78:79], v13 offset:19200
    v_mfma_f32_16x16x32_bf16 v[196:199], a[48:51], v[48:51], v[196:199]
    buffer_load_dwordx4 v11, s[16:19], s47 offen offset:2048 lds
    v_mfma_f32_16x16x32_bf16 v[196:199], a[60:63], v[52:55], v[196:199]
    ds_read_b128 v[68:71], v16 offset:0
    ds_read_b64_tr_b16 a[88:89], v13 offset:24576
    v_mfma_f32_16x16x32_bf16 v[200:203], a[40:43], v[44:47], v[24:27]
    ds_read_b128 v[72:75], v16 offset:64
    ds_read_b64_tr_b16 a[90:91], v13 offset:25344
    v_mfma_f32_16x16x32_bf16 v[200:203], a[52:55], v[48:51], v[200:203]
    buffer_load_dwordx4 v9, s[16:19], s47 offen offset:3072 lds
    v_mfma_f32_16x16x32_bf16 v[200:203], a[64:67], v[52:55], v[200:203]
    ds_read_b128 v[76:79], v16 offset:128
    ds_read_b64_tr_b16 a[100:101], v13 offset:30720
    v_mfma_f32_16x16x32_bf16 v[204:207], a[44:47], v[44:47], v[28:31]
    ds_read_b64_tr_b16 a[102:103], v13 offset:31488
    ds_read_b64_tr_b16 a[80:81], v12 offset:18496
    v_mfma_f32_16x16x32_bf16 v[204:207], a[56:59], v[48:51], v[204:207]
    buffer_load_dwordx4 v9, s[16:19], s47 offen offset:3584 lds
    v_mfma_f32_16x16x32_bf16 v[204:207], a[68:71], v[52:55], v[204:207]
    ds_read_b64_tr_b16 a[82:83], v12 offset:19264
    v_mfma_f32_16x16x32_bf16 v[208:211], a[36:39], v[56:59], v[20:23]
    ds_read_b64_tr_b16 a[92:93], v12 offset:24640
    v_mfma_f32_16x16x32_bf16 v[208:211], a[48:51], v[60:63], v[208:211]
    ds_read_b64_tr_b16 a[94:95], v12 offset:25408
    v_mfma_f32_16x16x32_bf16 v[208:211], a[60:63], v[64:67], v[208:211]
    s_mov_b32 s47, 129024
    s_add_u32 m0, s34, 94464
    v_mfma_f32_16x16x32_bf16 v[212:215], a[40:43], v[56:59], v[24:27]
    buffer_load_dwordx4 v9, s[16:19], s47 offen offset:0 lds
    v_mfma_f32_16x16x32_bf16 v[212:215], a[52:55], v[60:63], v[212:215]
    ds_read_b64_tr_b16 a[104:105], v12 offset:30784
    v_mfma_f32_16x16x32_bf16 v[212:215], a[64:67], v[64:67], v[212:215]
    ds_read_b64_tr_b16 a[106:107], v12 offset:31552
    v_mfma_f32_16x16x32_bf16 v[216:219], a[44:47], v[56:59], v[28:31]
    buffer_load_dwordx4 v10, s[16:19], s47 offen offset:1024 lds
    v_mfma_f32_16x16x32_bf16 v[216:219], a[56:59], v[60:63], v[216:219]
    v_mfma_f32_16x16x32_bf16 v[216:219], a[68:71], v[64:67], v[216:219]
    s_waitcnt lgkmcnt(7)
    v_mfma_f32_16x16x32_bf16 v[148:151], a[72:75], v[32:35], v[20:23]
    s_waitcnt vmcnt(7)
    v_mfma_f32_16x16x32_bf16 v[148:151], a[84:87], v[36:39], v[148:151]
    s_barrier
    v_add_u32 v12, 0xffff2800, v12
    v_mfma_f32_16x16x32_bf16 v[148:151], a[96:99], v[40:43], v[148:151]
    buffer_load_dwordx4 v11, s[16:19], s47 offen offset:2048 lds
    v_add_u32 v13, 0xffff2800, v13
    v_mfma_f32_16x16x32_bf16 v[152:155], a[76:79], v[32:35], v[24:27]
    ds_read_b64_tr_b16 a[108:109], v12 offset:0
    ds_read_b64_tr_b16 a[110:111], v12 offset:768
    v_mfma_f32_16x16x32_bf16 v[152:155], a[88:91], v[36:39], v[152:155]
    ds_read_b64_tr_b16 a[120:121], v12 offset:6144
    ds_read_b64_tr_b16 a[122:123], v12 offset:6912
    s_waitcnt lgkmcnt(6)
    v_mfma_f32_16x16x32_bf16 v[152:155], a[100:103], v[40:43], v[152:155]
    buffer_load_dwordx4 v9, s[16:19], s47 offen offset:3072 lds
    v_mfma_f32_16x16x32_bf16 v[156:159], a[80:83], v[32:35], v[28:31]
    ds_read_b64_tr_b16 a[132:133], v12 offset:12288
    ds_read_b64_tr_b16 a[134:135], v12 offset:13056
    v_mfma_f32_16x16x32_bf16 v[156:159], a[92:95], v[36:39], v[156:159]
    ds_read_b64_tr_b16 a[112:113], v13 offset:0
    ds_read_b64_tr_b16 a[114:115], v13 offset:768
    s_waitcnt lgkmcnt(8)
    v_mfma_f32_16x16x32_bf16 v[156:159], a[104:107], v[40:43], v[156:159]
    buffer_load_dwordx4 v9, s[16:19], s47 offen offset:3584 lds
    v_mfma_f32_16x16x32_bf16 v[160:163], a[72:75], v[44:47], v[20:23]
    ds_read_b64_tr_b16 a[124:125], v13 offset:6144
    v_mfma_f32_16x16x32_bf16 v[160:163], a[84:87], v[48:51], v[160:163]
    ds_read_b64_tr_b16 a[126:127], v13 offset:6912
    v_mfma_f32_16x16x32_bf16 v[160:163], a[96:99], v[52:55], v[160:163]
    s_mov_b32 s47, 36864
    s_add_u32 m0, s34, 19200
    v_mfma_f32_16x16x32_bf16 v[164:167], a[76:79], v[44:47], v[24:27]
    buffer_load_dwordx4 v9, s[16:19], s47 offen offset:0 lds
    v_mfma_f32_16x16x32_bf16 v[164:167], a[88:91], v[48:51], v[164:167]
    ds_read_b64_tr_b16 a[136:137], v13 offset:12288
    v_mfma_f32_16x16x32_bf16 v[164:167], a[100:103], v[52:55], v[164:167]
    ds_read_b64_tr_b16 a[138:139], v13 offset:13056
    v_mfma_f32_16x16x32_bf16 v[168:171], a[80:83], v[44:47], v[28:31]
    buffer_load_dwordx4 v10, s[16:19], s47 offen offset:1024 lds
    v_mfma_f32_16x16x32_bf16 v[168:171], a[92:95], v[48:51], v[168:171]
    ds_read_b64_tr_b16 a[116:117], v12 offset:64
    v_mfma_f32_16x16x32_bf16 v[168:171], a[104:107], v[52:55], v[168:171]
    ds_read_b64_tr_b16 a[118:119], v12 offset:832
    v_mfma_f32_16x16x32_bf16 v[172:175], a[72:75], v[56:59], v[20:23]
    buffer_load_dwordx4 v11, s[16:19], s47 offen offset:2048 lds
    v_mfma_f32_16x16x32_bf16 v[172:175], a[84:87], v[60:63], v[172:175]
    ds_read_b64_tr_b16 a[128:129], v12 offset:6208
    v_mfma_f32_16x16x32_bf16 v[172:175], a[96:99], v[64:67], v[172:175]
    ds_read_b64_tr_b16 a[130:131], v12 offset:6976
    v_mfma_f32_16x16x32_bf16 v[176:179], a[76:79], v[56:59], v[24:27]
    buffer_load_dwordx4 v9, s[16:19], s47 offen offset:3072 lds
    v_mfma_f32_16x16x32_bf16 v[176:179], a[88:91], v[60:63], v[176:179]
    ds_read_b64_tr_b16 a[140:141], v12 offset:12352
    v_mfma_f32_16x16x32_bf16 v[176:179], a[100:103], v[64:67], v[176:179]
    ds_read_b64_tr_b16 a[142:143], v12 offset:13120
    v_mfma_f32_16x16x32_bf16 v[180:183], a[80:83], v[56:59], v[28:31]
    buffer_load_dwordx4 v9, s[16:19], s47 offen offset:3584 lds
    v_mfma_f32_16x16x32_bf16 v[180:183], a[92:95], v[60:63], v[180:183]
    v_mfma_f32_16x16x32_bf16 v[180:183], a[104:107], v[64:67], v[180:183]
    s_waitcnt lgkmcnt(6)
    v_mfma_f32_16x16x32_bf16 v[220:223], a[108:111], v[44:47], v[220:223]
    s_waitcnt vmcnt(10)
    v_mfma_f32_16x16x32_bf16 v[220:223], a[120:123], v[48:51], v[220:223]
    s_barrier
    v_mfma_f32_16x16x32_bf16 v[220:223], a[132:135], v[52:55], v[220:223]
    s_mov_b32 s47, 92160
    s_add_u32 m0, s34, 112896
    ds_read_b64_tr_b16 a[144:145], v12 offset:18432
    v_mfma_f32_16x16x32_bf16 v[224:227], a[112:115], v[44:47], v[224:227]
    buffer_load_dwordx4 v9, s[16:19], s47 offen offset:0 lds
    v_mfma_f32_16x16x32_bf16 v[224:227], a[124:127], v[48:51], v[224:227]
    ds_read_b64_tr_b16 a[146:147], v12 offset:19200
    ds_read_b64_tr_b16 a[156:157], v12 offset:24576
    v_mfma_f32_16x16x32_bf16 v[224:227], a[136:139], v[52:55], v[224:227]
    ds_read_b64_tr_b16 a[158:159], v12 offset:25344
    ds_read_b64_tr_b16 a[168:169], v12 offset:30720
    s_waitcnt lgkmcnt(7)
    v_mfma_f32_16x16x32_bf16 v[228:231], a[116:119], v[44:47], v[228:231]
    buffer_load_dwordx4 v10, s[16:19], s47 offen offset:1024 lds
    v_mfma_f32_16x16x32_bf16 v[228:231], a[128:131], v[48:51], v[228:231]
    ds_read_b64_tr_b16 a[170:171], v12 offset:31488
    ds_read_b64_tr_b16 a[148:149], v13 offset:18432
    s_waitcnt lgkmcnt(7)
    v_mfma_f32_16x16x32_bf16 v[228:231], a[140:143], v[52:55], v[228:231]
    ds_read_b64_tr_b16 a[150:151], v13 offset:19200
    v_mfma_f32_16x16x32_bf16 v[232:235], a[108:111], v[56:59], v[232:235]
    buffer_load_dwordx4 v11, s[16:19], s47 offen offset:2048 lds
    v_mfma_f32_16x16x32_bf16 v[232:235], a[120:123], v[60:63], v[232:235]
    ds_read_b64_tr_b16 a[160:161], v13 offset:24576
    v_mfma_f32_16x16x32_bf16 v[232:235], a[132:135], v[64:67], v[232:235]
    ds_read_b64_tr_b16 a[162:163], v13 offset:25344
    v_mfma_f32_16x16x32_bf16 v[236:239], a[112:115], v[56:59], v[236:239]
    buffer_load_dwordx4 v9, s[16:19], s47 offen offset:3072 lds
    v_mfma_f32_16x16x32_bf16 v[236:239], a[124:127], v[60:63], v[236:239]
    ds_read_b64_tr_b16 a[172:173], v13 offset:30720
    v_mfma_f32_16x16x32_bf16 v[236:239], a[136:139], v[64:67], v[236:239]
    ds_read_b64_tr_b16 a[174:175], v13 offset:31488
    v_mfma_f32_16x16x32_bf16 v[240:243], a[116:119], v[56:59], v[240:243]
    buffer_load_dwordx4 v9, s[16:19], s47 offen offset:3584 lds
    v_mfma_f32_16x16x32_bf16 v[240:243], a[128:131], v[60:63], v[240:243]
    ds_read_b64_tr_b16 a[152:153], v12 offset:18496
    v_mfma_f32_16x16x32_bf16 v[240:243], a[140:143], v[64:67], v[240:243]
    ds_read_b64_tr_b16 a[154:155], v12 offset:19264
    v_mfma_f32_16x16x32_bf16 v[244:247], a[108:111], v[68:71], v[244:247]
    s_mov_b32 s47, 147456
    s_add_u32 m0, s34, 131328
    v_mfma_f32_16x16x32_bf16 v[244:247], a[120:123], v[72:75], v[244:247]
    buffer_load_dwordx4 v9, s[16:19], s47 offen offset:0 lds
    v_mfma_f32_16x16x32_bf16 v[244:247], a[132:135], v[76:79], v[244:247]
    ds_read_b64_tr_b16 a[164:165], v12 offset:24640
    v_mfma_f32_16x16x32_bf16 v[248:251], a[112:115], v[68:71], v[248:251]
    ds_read_b64_tr_b16 a[166:167], v12 offset:25408
    v_mfma_f32_16x16x32_bf16 v[248:251], a[124:127], v[72:75], v[248:251]
    buffer_load_dwordx4 v10, s[16:19], s47 offen offset:1024 lds
    v_mfma_f32_16x16x32_bf16 v[248:251], a[136:139], v[76:79], v[248:251]
    ds_read_b64_tr_b16 a[176:177], v12 offset:30784
    v_mfma_f32_16x16x32_bf16 v[252:255], a[116:119], v[68:71], v[252:255]
    ds_read_b64_tr_b16 a[178:179], v12 offset:31552
    v_mfma_f32_16x16x32_bf16 v[252:255], a[128:131], v[72:75], v[252:255]
    buffer_load_dwordx4 v11, s[16:19], s47 offen offset:2048 lds
    v_mfma_f32_16x16x32_bf16 v[252:255], a[140:143], v[76:79], v[252:255]
    s_waitcnt lgkmcnt(6)
    v_mfma_f32_16x16x32_bf16 v[184:187], a[144:147], v[44:47], v[184:187]
    s_waitcnt vmcnt(13)
    v_mfma_f32_16x16x32_bf16 v[184:187], a[156:159], v[48:51], v[184:187]
    s_barrier
    v_mfma_f32_16x16x32_bf16 v[184:187], a[168:171], v[52:55], v[184:187]
    buffer_load_dwordx4 v9, s[16:19], s47 offen offset:3072 lds
    v_mfma_f32_16x16x32_bf16 v[188:191], a[148:151], v[44:47], v[188:191]
    ds_read_b64_tr_b16 a[180:181], v12 offset:36864
    ds_read_b64_tr_b16 a[182:183], v12 offset:37632
    v_mfma_f32_16x16x32_bf16 v[188:191], a[160:163], v[48:51], v[188:191]
    ds_read_b64_tr_b16 a[192:193], v12 offset:43008
    ds_read_b64_tr_b16 a[194:195], v12 offset:43776
    v_mfma_f32_16x16x32_bf16 v[188:191], a[172:175], v[52:55], v[188:191]
    buffer_load_dwordx4 v9, s[16:19], s47 offen offset:3584 lds
    s_waitcnt lgkmcnt(7)
    v_mfma_f32_16x16x32_bf16 v[192:195], a[152:155], v[44:47], v[192:195]
    ds_read_b64_tr_b16 a[204:205], v12 offset:49152
    ds_read_b64_tr_b16 a[206:207], v12 offset:49920
    s_waitcnt lgkmcnt(8)
    v_mfma_f32_16x16x32_bf16 v[192:195], a[164:167], v[48:51], v[192:195]
    s_add_u32 m0, s33, 38400
    ds_read_b64_tr_b16 a[184:185], v13 offset:36864
    s_waitcnt lgkmcnt(7)
    v_mfma_f32_16x16x32_bf16 v[192:195], a[176:179], v[52:55], v[192:195]
    buffer_load_dwordx4 v4, s[12:15], s39 offen offset:0 nt lds
    v_mfma_f32_16x16x32_bf16 v[196:199], a[144:147], v[56:59], v[196:199]
    ds_read_b64_tr_b16 a[186:187], v13 offset:37632
    ds_read_b64_tr_b16 a[196:197], v13 offset:43008
    v_mfma_f32_16x16x32_bf16 v[196:199], a[156:159], v[60:63], v[196:199]
    ds_read_b64_tr_b16 a[198:199], v13 offset:43776
    ds_read_b64_tr_b16 a[208:209], v13 offset:49152
    v_mfma_f32_16x16x32_bf16 v[196:199], a[168:171], v[64:67], v[196:199]
    buffer_load_dwordx4 v5, s[12:15], s39 offen offset:2048 nt lds
    v_mfma_f32_16x16x32_bf16 v[200:203], a[148:151], v[56:59], v[200:203]
    ds_read_b128 v[32:35], v17 offset:0
    ds_read_b64_tr_b16 a[210:211], v13 offset:49920
    v_mfma_f32_16x16x32_bf16 v[200:203], a[160:163], v[60:63], v[200:203]
    ds_read_b128 v[36:39], v17 offset:64
    v_mfma_f32_16x16x32_bf16 v[200:203], a[172:175], v[64:67], v[200:203]
    s_add_u32 m0, s33, 42496
    ds_read_b128 v[40:43], v17 offset:128
    v_mfma_f32_16x16x32_bf16 v[204:207], a[152:155], v[56:59], v[204:207]
    buffer_load_dwordx4 v6, s[12:15], s39 offen offset:0 nt lds
    v_mfma_f32_16x16x32_bf16 v[204:207], a[164:167], v[60:63], v[204:207]
    ds_read_b64_tr_b16 a[188:189], v12 offset:36928
    v_mfma_f32_16x16x32_bf16 v[204:207], a[176:179], v[64:67], v[204:207]
    ds_read_b64_tr_b16 a[190:191], v12 offset:37696
    v_mfma_f32_16x16x32_bf16 v[208:211], a[144:147], v[68:71], v[208:211]
    buffer_load_dwordx4 v7, s[12:15], s39 offen offset:2048 nt lds
    v_mfma_f32_16x16x32_bf16 v[208:211], a[156:159], v[72:75], v[208:211]
    ds_read_b64_tr_b16 a[200:201], v12 offset:43072
    v_mfma_f32_16x16x32_bf16 v[208:211], a[168:171], v[76:79], v[208:211]
    ds_read_b64_tr_b16 a[202:203], v12 offset:43840
    v_mfma_f32_16x16x32_bf16 v[212:215], a[148:151], v[68:71], v[212:215]
    buffer_load_dwordx4 v8, s[12:15], s39 offen offset:3456 nt lds
    v_mfma_f32_16x16x32_bf16 v[212:215], a[160:163], v[72:75], v[212:215]
    ds_read_b64_tr_b16 a[212:213], v12 offset:49216
    v_mfma_f32_16x16x32_bf16 v[212:215], a[172:175], v[76:79], v[212:215]
    ds_read_b64_tr_b16 a[214:215], v12 offset:49984
    v_mfma_f32_16x16x32_bf16 v[216:219], a[152:155], v[68:71], v[216:219]
    v_mfma_f32_16x16x32_bf16 v[216:219], a[164:167], v[72:75], v[216:219]
    v_mfma_f32_16x16x32_bf16 v[216:219], a[176:179], v[76:79], v[216:219]
    s_waitcnt lgkmcnt(6)
    v_mfma_f32_16x16x32_bf16 v[148:151], a[180:183], v[44:47], v[148:151]
    s_waitcnt vmcnt(15)
    v_mfma_f32_16x16x32_bf16 v[148:151], a[192:195], v[48:51], v[148:151]
    s_barrier
    v_mfma_f32_16x16x32_bf16 v[148:151], a[204:207], v[52:55], v[148:151]
    v_add_u32 v12, 0xffff6a00, v12
    v_add_u32 v13, 0xffff6a00, v13
    v_mfma_f32_16x16x32_bf16 v[152:155], a[184:187], v[44:47], v[152:155]
L_pad0:
    s_cbranch_vccnz L_padret
    ds_read_b64_tr_b16 a[216:217], v12 offset:0
    v_mfma_f32_16x16x32_bf16 v[152:155], a[196:199], v[48:51], v[152:155]
    ds_read_b64_tr_b16 a[218:219], v12 offset:768
    v_mfma_f32_16x16x32_bf16 v[152:155], a[208:211], v[52:55], v[152:155]
    ds_read_b64_tr_b16 a[228:229], v12 offset:6144
    s_waitcnt lgkmcnt(5)
    v_mfma_f32_16x16x32_bf16 v[156:159], a[188:191], v[44:47], v[156:159]
    ds_read_b64_tr_b16 a[230:231], v12 offset:6912
    v_mfma_f32_16x16x32_bf16 v[156:159], a[200:203], v[48:51], v[156:159]
    ds_read_b64_tr_b16 a[240:241], v12 offset:12288
    s_waitcnt lgkmcnt(5)
    v_mfma_f32_16x16x32_bf16 v[156:159], a[212:215], v[52:55], v[156:159]
    ds_read_b64_tr_b16 a[242:243], v12 offset:13056
    v_mfma_f32_16x16x32_bf16 v[160:163], a[180:183], v[56:59], v[160:163]
    ds_read_b64_tr_b16 a[220:221], v13 offset:0
    v_mfma_f32_16x16x32_bf16 v[160:163], a[192:195], v[60:63], v[160:163]
    ds_read_b64_tr_b16 a[222:223], v13 offset:768
    v_mfma_f32_16x16x32_bf16 v[160:163], a[204:207], v[64:67], v[160:163]
    ds_read_b64_tr_b16 a[232:233], v13 offset:6144
    v_mfma_f32_16x16x32_bf16 v[164:167], a[184:187], v[56:59], v[164:167]
    ds_read_b64_tr_b16 a[234:235], v13 offset:6912
    v_mfma_f32_16x16x32_bf16 v[164:167], a[196:199], v[60:63], v[164:167]
    ds_read_b64_tr_b16 a[244:245], v13 offset:12288
    v_mfma_f32_16x16x32_bf16 v[164:167], a[208:211], v[64:67], v[164:167]
    ds_read_b64_tr_b16 a[246:247], v13 offset:13056
    v_mfma_f32_16x16x32_bf16 v[168:171], a[188:191], v[56:59], v[168:171]
    ds_read_b64_tr_b16 a[224:225], v12 offset:64
    v_mfma_f32_16x16x32_bf16 v[168:171], a[200:203], v[60:63], v[168:171]
    ds_read_b64_tr_b16 a[226:227], v12 offset:832
    v_mfma_f32_16x16x32_bf16 v[168:171], a[212:215], v[64:67], v[168:171]
    ds_read_b64_tr_b16 a[236:237], v12 offset:6208
    v_mfma_f32_16x16x32_bf16 v[172:175], a[180:183], v[68:71], v[172:175]
    ds_read_b64_tr_b16 a[238:239], v12 offset:6976
    v_mfma_f32_16x16x32_bf16 v[172:175], a[192:195], v[72:75], v[172:175]
    ds_read_b64_tr_b16 a[248:249], v12 offset:12352
    v_mfma_f32_16x16x32_bf16 v[172:175], a[204:207], v[76:79], v[172:175]
    ds_read_b64_tr_b16 a[250:251], v12 offset:13120
    v_mfma_f32_16x16x32_bf16 v[176:179], a[184:187], v[68:71], v[176:179]
    v_mfma_f32_16x16x32_bf16 v[176:179], a[196:199], v[72:75], v[176:179]
    v_mfma_f32_16x16x32_bf16 v[176:179], a[208:211], v[76:79], v[176:179]
    v_mfma_f32_16x16x32_bf16 v[180:183], a[188:191], v[68:71], v[180:183]
    v_mfma_f32_16x16x32_bf16 v[180:183], a[200:203], v[72:75], v[180:183]
    v_mfma_f32_16x16x32_bf16 v[180:183], a[212:215], v[76:79], v[180:183]
    s_waitcnt lgkmcnt(6)
    v_mfma_f32_16x16x32_bf16 v[220:223], a[216:219], v[56:59], v[220:223]
    s_waitcnt vmcnt(10)
    v_mfma_f32_16x16x32_bf16 v[220:223], a[228:231], v[60:63], v[220:223]
    s_barrier
    v_add_u32 v12, 0x16e00, v12
    v_mfma_f32_16x16x32_bf16 v[220:223], a[240:243], v[64:67], v[220:223]
    s_add_u32 s46, s31, 73728
    s_add_u32 m0, s33, 67200
    v_add_u32 v13, 0x16e00, v13
    v_mfma_f32_16x16x32_bf16 v[224:227], a[220:223], v[56:59], v[224:227]
    buffer_load_dwordx4 v4, s[12:15], s46 offen offset:0 nt lds
    v_mfma_f32_16x16x32_bf16 v[224:227], a[232:235], v[60:63], v[224:227]
    ds_read_b64_tr_b16 a[252:253], v12 offset:0
    ds_read_b64_tr_b16 a[254:255], v12 offset:768
    v_mfma_f32_16x16x32_bf16 v[224:227], a[244:247], v[64:67], v[224:227]
    ds_read_b64_tr_b16 v[88:89], v12 offset:6144
    s_waitcnt lgkmcnt(3)
    v_mfma_f32_16x16x32_bf16 v[228:231], a[224:227], v[56:59], v[228:231]
    buffer_load_dwordx4 v5, s[12:15], s46 offen offset:2048 nt lds
    v_mfma_f32_16x16x32_bf16 v[228:231], a[236:239], v[60:63], v[228:231]
    ds_read_b64_tr_b16 v[90:91], v12 offset:6912
    v_mfma_f32_16x16x32_bf16 v[228:231], a[248:251], v[64:67], v[228:231]
    ds_read_b64_tr_b16 v[100:101], v12 offset:12288
    v_mfma_f32_16x16x32_bf16 v[232:235], a[216:219], v[68:71], v[232:235]
    s_add_u32 m0, s33, 71296
    ds_read_b64_tr_b16 v[102:103], v12 offset:13056
    v_mfma_f32_16x16x32_bf16 v[232:235], a[228:231], v[72:75], v[232:235]
    buffer_load_dwordx4 v6, s[12:15], s46 offen offset:0 nt lds
    v_mfma_f32_16x16x32_bf16 v[232:235], a[240:243], v[76:79], v[232:235]
    ds_read_b64_tr_b16 v[80:81], v13 offset:0
    v_mfma_f32_16x16x32_bf16 v[236:239], a[220:223], v[68:71], v[236:239]
    ds_read_b64_tr_b16 v[82:83], v13 offset:768
    v_mfma_f32_16x16x32_bf16 v[236:239], a[232:235], v[72:75], v[236:239]
    buffer_load_dwordx4 v7, s[12:15], s46 offen offset:2048 nt lds
    v_mfma_f32_16x16x32_bf16 v[236:239], a[244:247], v[76:79], v[236:239]
    ds_read_b64_tr_b16 v[92:93], v13 offset:6144
    v_mfma_f32_16x16x32_bf16 v[240:243], a[224:227], v[68:71], v[240:243]
    ds_read_b64_tr_b16 v[94:95], v13 offset:6912
    v_mfma_f32_16x16x32_bf16 v[240:243], a[236:239], v[72:75], v[240:243]
    buffer_load_dwordx4 v8, s[12:15], s46 offen offset:3456 nt lds
    v_mfma_f32_16x16x32_bf16 v[240:243], a[248:251], v[76:79], v[240:243]
    ds_read_b64_tr_b16 v[104:105], v13 offset:12288
    v_mfma_f32_16x16x32_bf16 v[244:247], a[216:219], v[32:35], v[244:247]
    ds_read_b64_tr_b16 v[106:107], v13 offset:13056
    v_mfma_f32_16x16x32_bf16 v[244:247], a[228:231], v[36:39], v[244:247]
    ds_read_b64_tr_b16 v[84:85], v12 offset:64
    v_mfma_f32_16x16x32_bf16 v[244:247], a[240:243], v[40:43], v[244:247]
    ds_read_b64_tr_b16 v[86:87], v12 offset:832
    v_mfma_f32_16x16x32_bf16 v[248:251], a[220:223], v[32:35], v[248:251]
    ds_read_b64_tr_b16 v[96:97], v12 offset:6208
    v_mfma_f32_16x16x32_bf16 v[248:251], a[232:235], v[36:39], v[248:251]
    ds_read_b64_tr_b16 v[98:99], v12 offset:6976
    v_mfma_f32_16x16x32_bf16 v[248:251], a[244:247], v[40:43], v[248:251]
    ds_read_b64_tr_b16 v[108:109], v12 offset:12352
    v_mfma_f32_16x16x32_bf16 v[252:255], a[224:227], v[32:35], v[252:255]
    ds_read_b64_tr_b16 v[110:111], v12 offset:13120
    v_mfma_f32_16x16x32_bf16 v[252:255], a[236:239], v[36:39], v[252:255]
    v_mfma_f32_16x16x32_bf16 v[252:255], a[248:251], v[40:43], v[252:255]
    s_waitcnt lgkmcnt(9)
    v_mfma_f32_16x16x32_bf16 v[184:187], a[252:255], v[56:59], v[184:187]
    s_waitcnt vmcnt(10)
    v_mfma_f32_16x16x32_bf16 v[184:187], v[88:91], v[60:63], v[184:187]
    s_barrier
    v_mfma_f32_16x16x32_bf16 v[184:187], v[100:103], v[64:67], v[184:187]
    ds_read_b64_tr_b16 v[112:113], v12 offset:18432
    v_mfma_f32_16x16x32_bf16 v[188:191], v[80:83], v[56:59], v[188:191]
    ds_read_b64_tr_b16 v[114:115], v12 offset:19200
    s_waitcnt lgkmcnt(8)
    v_mfma_f32_16x16x32_bf16 v[188:191], v[92:95], v[60:63], v[188:191]
    ds_read_b64_tr_b16 v[124:125], v12 offset:24576
    v_mfma_f32_16x16x32_bf16 v[188:191], v[104:107], v[64:67], v[188:191]
    ds_read_b64_tr_b16 v[126:127], v12 offset:25344
    s_waitcnt lgkmcnt(8)
    v_mfma_f32_16x16x32_bf16 v[192:195], v[84:87], v[56:59], v[192:195]
    ds_read_b64_tr_b16 v[136:137], v12 offset:30720
    s_waitcnt lgkmcnt(7)
    v_mfma_f32_16x16x32_bf16 v[192:195], v[96:99], v[60:63], v[192:195]
    ds_read_b64_tr_b16 v[138:139], v12 offset:31488
    s_waitcnt lgkmcnt(6)
    v_mfma_f32_16x16x32_bf16 v[192:195], v[108:111], v[64:67], v[192:195]
    ds_read_b64_tr_b16 v[116:117], v13 offset:18432
    v_mfma_f32_16x16x32_bf16 v[196:199], a[252:255], v[68:71], v[196:199]
    ds_read_b64_tr_b16 v[118:119], v13 offset:19200
    v_mfma_f32_16x16x32_bf16 v[196:199], v[88:91], v[72:75], v[196:199]
    ds_read_b64_tr_b16 v[128:129], v13 offset:24576
    v_mfma_f32_16x16x32_bf16 v[196:199], v[100:103], v[76:79], v[196:199]
    ds_read_b64_tr_b16 v[130:131], v13 offset:25344
    v_mfma_f32_16x16x32_bf16 v[200:203], v[80:83], v[68:71], v[200:203]
    ds_read_b64_tr_b16 v[140:141], v13 offset:30720
    v_mfma_f32_16x16x32_bf16 v[200:203], v[92:95], v[72:75], v[200:203]
    ds_read_b64_tr_b16 v[142:143], v13 offset:31488
    v_mfma_f32_16x16x32_bf16 v[200:203], v[104:107], v[76:79], v[200:203]
    ds_read_b64_tr_b16 v[120:121], v12 offset:18496
    v_mfma_f32_16x16x32_bf16 v[204:207], v[84:87], v[68:71], v[204:207]
    ds_read_b64_tr_b16 v[122:123], v12 offset:19264
    v_mfma_f32_16x16x32_bf16 v[204:207], v[96:99], v[72:75], v[204:207]
    ds_read_b64_tr_b16 v[132:133], v12 offset:24640
    v_mfma_f32_16x16x32_bf16 v[204:207], v[108:111], v[76:79], v[204:207]
    ds_read_b64_tr_b16 v[134:135], v12 offset:25408
    v_mfma_f32_16x16x32_bf16 v[208:211], a[252:255], v[32:35], v[208:211]
    ds_read_b64_tr_b16 v[144:145], v12 offset:30784
    v_mfma_f32_16x16x32_bf16 v[208:211], v[88:91], v[36:39], v[208:211]
    ds_read_b64_tr_b16 v[146:147], v12 offset:31552
    v_mfma_f32_16x16x32_bf16 v[208:211], v[100:103], v[40:43], v[208:211]
    v_mfma_f32_16x16x32_bf16 v[212:215], v[80:83], v[32:35], v[212:215]
    v_mfma_f32_16x16x32_bf16 v[212:215], v[92:95], v[36:39], v[212:215]
    v_mfma_f32_16x16x32_bf16 v[212:215], v[104:107], v[40:43], v[212:215]
    v_mfma_f32_16x16x32_bf16 v[216:219], v[84:87], v[32:35], v[216:219]
    v_mfma_f32_16x16x32_bf16 v[216:219], v[96:99], v[36:39], v[216:219]
    v_mfma_f32_16x16x32_bf16 v[216:219], v[108:111], v[40:43], v[216:219]
    s_waitcnt lgkmcnt(5)
    v_mfma_f32_16x16x32_bf16 v[148:151], v[112:115], v[56:59], v[148:151]
    v_mfma_f32_16x16x32_bf16 v[148:151], v[124:127], v[60:63], v[148:151]
    v_mfma_f32_16x16x32_bf16 v[148:151], v[136:139], v[64:67], v[148:151]
    v_mfma_f32_16x16x32_bf16 v[152:155], v[116:119], v[56:59], v[152:155]
    v_mfma_f32_16x16x32_bf16 v[152:155], v[128:131], v[60:63], v[152:155]
    v_mfma_f32_16x16x32_bf16 v[152:155], v[140:143], v[64:67], v[152:155]
    s_waitcnt lgkmcnt(0)
    v_mfma_f32_16x16x32_bf16 v[156:159], v[120:123], v[56:59], v[156:159]
    v_mfma_f32_16x16x32_bf16 v[156:159], v[132:135], v[60:63], v[156:159]
    v_mfma_f32_16x16x32_bf16 v[156:159], v[144:147], v[64:67], v[156:159]
    v_mfma_f32_16x16x32_bf16 v[160:163], v[112:115], v[68:71], v[160:163]
    s_waitcnt vmcnt(5)
    v_mfma_f32_16x16x32_bf16 v[160:163], v[124:127], v[72:75], v[160:163]
    s_barrier
    v_mfma_f32_16x16x32_bf16 v[160:163], v[136:139], v[76:79], v[160:163]
    ds_read_b128 v[44:47], v1 offset:38400
    v_mfma_f32_16x16x32_bf16 v[164:167], v[116:119], v[68:71], v[164:167]
    ds_read_b128 v[48:51], v1 offset:38464
    v_mfma_f32_16x16x32_bf16 v[164:167], v[128:131], v[72:75], v[164:167]
    ds_read_b128 v[52:55], v1 offset:38528
    v_mfma_f32_16x16x32_bf16 v[164:167], v[140:143], v[76:79], v[164:167]
    ds_read_b128 v[56:59], v2 offset:38400
    v_mfma_f32_16x16x32_bf16 v[168:171], v[120:123], v[68:71], v[168:171]
    ds_read_b128 v[60:63], v2 offset:38464
    v_mfma_f32_16x16x32_bf16 v[168:171], v[132:135], v[72:75], v[168:171]
    ds_read_b128 v[64:67], v2 offset:38528
    v_mfma_f32_16x16x32_bf16 v[168:171], v[144:147], v[76:79], v[168:171]
    ds_read_b128 v[68:71], v3 offset:38400
    v_mfma_f32_16x16x32_bf16 v[172:175], v[112:115], v[32:35], v[172:175]
    ds_read_b128 v[72:75], v3 offset:38464
    v_mfma_f32_16x16x32_bf16 v[172:175], v[124:127], v[36:39], v[172:175]
    ds_read_b128 v[76:79], v3 offset:38528
    v_mfma_f32_16x16x32_bf16 v[172:175], v[136:139], v[40:43], v[172:175]
    v_mfma_f32_16x16x32_bf16 v[176:179], v[116:119], v[32:35], v[176:179]
    v_mfma_f32_16x16x32_bf16 v[176:179], v[128:131], v[36:39], v[176:179]
    v_mfma_f32_16x16x32_bf16 v[176:179], v[140:143], v[40:43], v[176:179]
    v_mfma_f32_16x16x32_bf16 v[180:183], v[120:123], v[32:35], v[180:183]
    ds_read_b128 v[32:35], v16 offset:38400
    v_mfma_f32_16x16x32_bf16 v[180:183], v[132:135], v[36:39], v[180:183]
    ds_read_b128 v[36:39], v16 offset:38464
    v_mfma_f32_16x16x32_bf16 v[180:183], v[144:147], v[40:43], v[180:183]
    ds_read_b128 v[40:43], v16 offset:38528
    s_waitcnt lgkmcnt(8)
    v_mfma_f32_16x16x32_bf16 v[148:151], a[0:3], v[44:47], v[148:151]
    v_mfma_f32_16x16x32_bf16 v[148:151], a[12:15], v[48:51], v[148:151]
    v_mfma_f32_16x16x32_bf16 v[148:151], a[24:27], v[52:55], v[148:151]
    v_mfma_f32_16x16x32_bf16 v[148:151], a[108:111], v[56:59], v[148:151]
    s_waitcnt lgkmcnt(4)
    v_mfma_f32_16x16x32_bf16 v[148:151], a[120:123], v[60:63], v[148:151]
    v_mfma_f32_16x16x32_bf16 v[148:151], a[132:135], v[64:67], v[148:151]
    v_mfma_f32_16x16x32_bf16 v[148:151], a[216:219], v[68:71], v[148:151]
    s_add_u32 s46, s31, 221184
    s_add_u32 m0, s33, 115200
    v_mfma_f32_16x16x32_bf16 v[148:151], a[228:231], v[72:75], v[148:151]
    buffer_load_dwordx4 v4, s[12:15], s46 offen offset:0 nt lds
    s_waitcnt lgkmcnt(3)
    v_mfma_f32_16x16x32_bf16 v[148:151], a[240:243], v[76:79], v[148:151]
    v_mfma_f32_16x16x32_bf16 v[152:155], a[4:7], v[44:47], v[152:155]
    v_mfma_f32_16x16x32_bf16 v[152:155], a[16:19], v[48:51], v[152:155]
    buffer_load_dwordx4 v5, s[12:15], s46 offen offset:2048 nt lds
    v_mfma_f32_16x16x32_bf16 v[152:155], a[28:31], v[52:55], v[152:155]
    v_mfma_f32_16x16x32_bf16 v[152:155], a[112:115], v[56:59], v[152:155]
    v_mfma_f32_16x16x32_bf16 v[152:155], a[124:127], v[60:63], v[152:155]
    s_add_u32 m0, s33, 119296
    v_mfma_f32_16x16x32_bf16 v[152:155], a[136:139], v[64:67], v[152:155]
    buffer_load_dwordx4 v6, s[12:15], s46 offen offset:0 nt lds
    v_mfma_f32_16x16x32_bf16 v[152:155], a[220:223], v[68:71], v[152:155]
    v_mfma_f32_16x16x32_bf16 v[152:155], a[232:235], v[72:75], v[152:155]
    v_mfma_f32_16x16x32_bf16 v[152:155], a[244:247], v[76:79], v[152:155]
    buffer_load_dwordx4 v7, s[12:15], s46 offen offset:2048 nt lds
    v_mfma_f32_16x16x32_bf16 v[156:159], a[8:11], v[44:47], v[156:159]
    ds_read_b128 v[44:47], v17 offset:38400
    v_mfma_f32_16x16x32_bf16 v[156:159], a[20:23], v[48:51], v[156:159]
    ds_read_b128 v[48:51], v17 offset:38464
    v_mfma_f32_16x16x32_bf16 v[156:159], a[32:35], v[52:55], v[156:159]
    buffer_load_dwordx4 v8, s[12:15], s46 offen offset:3456 nt lds
    v_mfma_f32_16x16x32_bf16 v[156:159], a[116:119], v[56:59], v[156:159]
    ds_read_b128 v[52:55], v17 offset:38528
    v_mfma_f32_16x16x32_bf16 v[156:159], a[128:131], v[60:63], v[156:159]
    v_mfma_f32_16x16x32_bf16 v[156:159], a[140:143], v[64:67], v[156:159]
    v_mfma_f32_16x16x32_bf16 v[156:159], a[224:227], v[68:71], v[156:159]
    v_mfma_f32_16x16x32_bf16 v[156:159], a[236:239], v[72:75], v[156:159]
    v_mfma_f32_16x16x32_bf16 v[156:159], a[248:251], v[76:79], v[156:159]
    s_mul_i32 s20, s29, 4608
    v_mfma_f32_16x16x32_bf16 v[160:163], a[0:3], v[56:59], v[160:163]
    s_add_u32 s20, s20, s35
    v_mfma_f32_16x16x32_bf16 v[160:163], a[12:15], v[60:63], v[160:163]
    s_mul_i32 s22, s29, 1536
    v_mfma_f32_16x16x32_bf16 v[160:163], a[24:27], v[64:67], v[160:163]
    s_add_u32 s22, s22, s35
    v_mfma_f32_16x16x32_bf16 v[160:163], a[108:111], v[68:71], v[160:163]
    s_movk_i32 s38, 911
    v_mfma_f32_16x16x32_bf16 v[160:163], a[120:123], v[72:75], v[160:163]
    v_add_u32 v18, 0, v0
    v_mfma_f32_16x16x32_bf16 v[160:163], a[132:135], v[76:79], v[160:163]
    v_mul_u32_u24 v9, s38, v18
    s_waitcnt lgkmcnt(1)
    v_mfma_f32_16x16x32_bf16 v[160:163], a[216:219], v[32:35], v[160:163]
    v_bfe_u32 v9, v9, 16, 2
    v_mfma_f32_16x16x32_bf16 v[160:163], a[228:231], v[36:39], v[160:163]
    v_xor_b32 v9, v9, v18
    v_mfma_f32_16x16x32_bf16 v[160:163], a[240:243], v[40:43], v[160:163]
    v_lshlrev_b32 v9, 4, v9
    v_mfma_f32_16x16x32_bf16 v[164:167], a[4:7], v[56:59], v[164:167]
    v_add_u32 v9, s34, v9
    v_mfma_f32_16x16x32_bf16 v[164:167], a[16:19], v[60:63], v[164:167]
    v_add_u32 v18, 64, v0
    v_mfma_f32_16x16x32_bf16 v[164:167], a[28:31], v[64:67], v[164:167]
    v_mul_u32_u24 v10, s38, v18
    v_mfma_f32_16x16x32_bf16 v[164:167], a[112:115], v[68:71], v[164:167]
    v_bfe_u32 v10, v10, 16, 2
    v_mfma_f32_16x16x32_bf16 v[164:167], a[124:127], v[72:75], v[164:167]
    v_xor_b32 v10, v10, v18
    v_mfma_f32_16x16x32_bf16 v[164:167], a[136:139], v[76:79], v[164:167]
    v_lshlrev_b32 v10, 4, v10
    v_mfma_f32_16x16x32_bf16 v[164:167], a[220:223], v[32:35], v[164:167]
    v_add_u32 v10, s34, v10
    v_mfma_f32_16x16x32_bf16 v[164:167], a[232:235], v[36:39], v[164:167]
    v_add_u32 v18, 128, v0
    v_mfma_f32_16x16x32_bf16 v[164:167], a[244:247], v[40:43], v[164:167]
    v_mul_u32_u24 v11, s38, v18
    v_mfma_f32_16x16x32_bf16 v[168:171], a[8:11], v[56:59], v[168:171]
    v_bfe_u32 v11, v11, 16, 2
    v_mfma_f32_16x16x32_bf16 v[168:171], a[20:23], v[60:63], v[168:171]
    v_xor_b32 v11, v11, v18
    v_mfma_f32_16x16x32_bf16 v[168:171], a[32:35], v[64:67], v[168:171]
    v_lshlrev_b32 v11, 4, v11
    v_mfma_f32_16x16x32_bf16 v[168:171], a[116:119], v[68:71], v[168:171]
    v_add_u32 v11, s34, v11
    v_mfma_f32_16x16x32_bf16 v[168:171], a[128:131], v[72:75], v[168:171]
    v_add_u32 v18, 192, v0
    v_mfma_f32_16x16x32_bf16 v[168:171], a[140:143], v[76:79], v[168:171]
    v_mul_u32_u24 v12, s38, v18
    v_mfma_f32_16x16x32_bf16 v[168:171], a[224:227], v[32:35], v[168:171]
    v_bfe_u32 v12, v12, 16, 2
    v_mfma_f32_16x16x32_bf16 v[168:171], a[236:239], v[36:39], v[168:171]
    v_xor_b32 v12, v12, v18
    v_mfma_f32_16x16x32_bf16 v[168:171], a[248:251], v[40:43], v[168:171]
    v_lshlrev_b32 v12, 4, v12
    v_mfma_f32_16x16x32_bf16 v[172:175], a[0:3], v[68:71], v[172:175]
    v_add_u32 v12, s34, v12
    v_mfma_f32_16x16x32_bf16 v[172:175], a[12:15], v[72:75], v[172:175]
    v_add_u32 v18, 224, v0
    v_mfma_f32_16x16x32_bf16 v[172:175], a[24:27], v[76:79], v[172:175]
    v_add_u32 v1, 0x10680, v1
    v_add_u32 v2, 0x10680, v2
    v_add_u32 v3, 0x10680, v3
    v_mfma_f32_16x16x32_bf16 v[172:175], a[108:111], v[32:35], v[172:175]
    v_add_u32 v16, 0x10680, v16
    v_add_u32 v17, 0x10680, v17
    v_mul_u32_u24 v13, s38, v18
    v_mfma_f32_16x16x32_bf16 v[172:175], a[120:123], v[36:39], v[172:175]
    v_bfe_u32 v13, v13, 16, 2
    v_mfma_f32_16x16x32_bf16 v[172:175], a[132:135], v[40:43], v[172:175]
    v_xor_b32 v13, v13, v18
    v_mfma_f32_16x16x32_bf16 v[172:175], a[216:219], v[44:47], v[172:175]
    v_lshlrev_b32 v13, 4, v13
    v_mfma_f32_16x16x32_bf16 v[172:175], a[228:231], v[48:51], v[172:175]
    v_add_u32 v13, s34, v13
    s_waitcnt lgkmcnt(0)
    v_mfma_f32_16x16x32_bf16 v[172:175], a[240:243], v[52:55], v[172:175]
    v_mfma_f32_16x16x32_bf16 v[176:179], a[4:7], v[68:71], v[176:179]
    s_waitcnt vmcnt(5)
    v_mfma_f32_16x16x32_bf16 v[176:179], a[16:19], v[72:75], v[176:179]
    s_barrier
    v_mfma_f32_16x16x32_bf16 v[176:179], a[28:31], v[76:79], v[176:179]
    ds_read_b128 v[56:59], v1 offset:0
    v_mfma_f32_16x16x32_bf16 v[176:179], a[112:115], v[32:35], v[176:179]
    ds_read_b128 v[60:63], v1 offset:64
    v_mfma_f32_16x16x32_bf16 v[176:179], a[124:127], v[36:39], v[176:179]
    ds_read_b128 v[64:67], v1 offset:128
    v_mfma_f32_16x16x32_bf16 v[176:179], a[136:139], v[40:43], v[176:179]
    v_mfma_f32_16x16x32_bf16 v[176:179], a[220:223], v[44:47], v[176:179]
    v_mfma_f32_16x16x32_bf16 v[176:179], a[232:235], v[48:51], v[176:179]
    v_mfma_f32_16x16x32_bf16 v[176:179], a[244:247], v[52:55], v[176:179]
    v_mfma_f32_16x16x32_bf16 v[180:183], a[8:11], v[68:71], v[180:183]
    ds_read_b128 v[68:71], v2 offset:0
    v_mfma_f32_16x16x32_bf16 v[180:183], a[20:23], v[72:75], v[180:183]
    ds_read_b128 v[72:75], v2 offset:64
    v_mfma_f32_16x16x32_bf16 v[180:183], a[32:35], v[76:79], v[180:183]
    ds_read_b128 v[76:79], v2 offset:128
    v_mfma_f32_16x16x32_bf16 v[180:183], a[116:119], v[32:35], v[180:183]
    ds_read_b128 v[32:35], v3 offset:0
    v_mfma_f32_16x16x32_bf16 v[180:183], a[128:131], v[36:39], v[180:183]
    ds_read_b128 v[36:39], v3 offset:64
    v_mfma_f32_16x16x32_bf16 v[180:183], a[140:143], v[40:43], v[180:183]
    ds_read_b128 v[40:43], v3 offset:128
    v_mfma_f32_16x16x32_bf16 v[180:183], a[224:227], v[44:47], v[180:183]
    v_mfma_f32_16x16x32_bf16 v[180:183], a[236:239], v[48:51], v[180:183]
    v_mfma_f32_16x16x32_bf16 v[180:183], a[248:251], v[52:55], v[180:183]
    ds_read_b128 v[44:47], v16 offset:0
    s_waitcnt lgkmcnt(7)
    v_mfma_f32_16x16x32_bf16 v[148:151], a[36:39], v[56:59], v[148:151]
    ds_read_b128 v[48:51], v16 offset:64
    v_mfma_f32_16x16x32_bf16 v[148:151], a[48:51], v[60:63], v[148:151]
    ds_read_b128 v[52:55], v16 offset:128
    v_mfma_f32_16x16x32_bf16 v[148:151], a[60:63], v[64:67], v[148:151]
    s_waitcnt lgkmcnt(8)
    v_mfma_f32_16x16x32_bf16 v[148:151], a[144:147], v[68:71], v[148:151]
    s_waitcnt lgkmcnt(7)
    v_mfma_f32_16x16x32_bf16 v[148:151], a[156:159], v[72:75], v[148:151]
    s_waitcnt lgkmcnt(6)
    v_mfma_f32_16x16x32_bf16 v[148:151], a[168:171], v[76:79], v[148:151]
    s_add_u32 s46, s31, 294912
    s_add_u32 m0, s33, 134400
    s_waitcnt lgkmcnt(5)
    v_mfma_f32_16x16x32_bf16 v[148:151], a[252:255], v[32:35], v[148:151]
    buffer_load_dwordx4 v4, s[12:15], s46 offen offset:0 nt lds
    s_waitcnt lgkmcnt(4)
    v_mfma_f32_16x16x32_bf16 v[148:151], v[88:91], v[36:39], v[148:151]
    s_waitcnt lgkmcnt(3)
    v_mfma_f32_16x16x32_bf16 v[148:151], v[100:103], v[40:43], v[148:151]
    v_mfma_f32_16x16x32_bf16 v[152:155], a[40:43], v[56:59], v[152:155]
    buffer_load_dwordx4 v5, s[12:15], s46 offen offset:2048 nt lds
    v_mfma_f32_16x16x32_bf16 v[152:155], a[52:55], v[60:63], v[152:155]
    v_mfma_f32_16x16x32_bf16 v[152:155], a[64:67], v[64:67], v[152:155]
    v_mfma_f32_16x16x32_bf16 v[152:155], a[148:151], v[68:71], v[152:155]
    s_add_u32 m0, s33, 138496
    v_mfma_f32_16x16x32_bf16 v[152:155], a[160:163], v[72:75], v[152:155]
    buffer_load_dwordx4 v6, s[12:15], s46 offen offset:0 nt lds
    v_mfma_f32_16x16x32_bf16 v[152:155], a[172:175], v[76:79], v[152:155]
    v_mfma_f32_16x16x32_bf16 v[152:155], v[80:83], v[32:35], v[152:155]
    v_mfma_f32_16x16x32_bf16 v[152:155], v[92:95], v[36:39], v[152:155]
    v_cvt_pk_bf16_f32 v148, v148, v149
    v_cvt_pk_bf16_f32 v149, v150, v151
    v_mfma_f32_16x16x32_bf16 v[152:155], v[104:107], v[40:43], v[152:155]
    ds_write_b32 v14, v148 offset:0
    v_mfma_f32_16x16x32_bf16 v[156:159], a[44:47], v[56:59], v[156:159]
    ds_write_b32 v14, v149 offset:4
    v_mfma_f32_16x16x32_bf16 v[156:159], a[56:59], v[60:63], v[156:159]
    v_mfma_f32_16x16x32_bf16 v[156:159], a[68:71], v[64:67], v[156:159]
    v_mfma_f32_16x16x32_bf16 v[156:159], a[152:155], v[68:71], v[156:159]
    v_mfma_f32_16x16x32_bf16 v[156:159], a[164:167], v[72:75], v[156:159]
    v_mfma_f32_16x16x32_bf16 v[156:159], a[176:179], v[76:79], v[156:159]
    buffer_load_dwordx4 v7, s[12:15], s46 offen offset:2048 nt lds
    v_mfma_f32_16x16x32_bf16 v[156:159], v[84:87], v[32:35], v[156:159]
    v_mfma_f32_16x16x32_bf16 v[156:159], v[96:99], v[36:39], v[156:159]
    v_cvt_pk_bf16_f32 v152, v152, v153
    v_cvt_pk_bf16_f32 v153, v154, v155
    v_mfma_f32_16x16x32_bf16 v[156:159], v[108:111], v[40:43], v[156:159]
    ds_write_b32 v15, v152 offset:0
    v_mfma_f32_16x16x32_bf16 v[184:187], a[0:3], v[56:59], v[184:187]
    ds_write_b32 v15, v153 offset:4
    v_mfma_f32_16x16x32_bf16 v[184:187], a[12:15], v[60:63], v[184:187]
    v_mfma_f32_16x16x32_bf16 v[184:187], a[24:27], v[64:67], v[184:187]
    v_mfma_f32_16x16x32_bf16 v[184:187], a[108:111], v[68:71], v[184:187]
    v_mfma_f32_16x16x32_bf16 v[184:187], a[120:123], v[72:75], v[184:187]
    v_mfma_f32_16x16x32_bf16 v[184:187], a[132:135], v[76:79], v[184:187]
    buffer_load_dwordx4 v8, s[12:15], s46 offen offset:3456 nt lds
    v_mfma_f32_16x16x32_bf16 v[184:187], a[216:219], v[32:35], v[184:187]
    v_mfma_f32_16x16x32_bf16 v[184:187], a[228:231], v[36:39], v[184:187]
    v_cvt_pk_bf16_f32 v156, v156, v157
    v_cvt_pk_bf16_f32 v157, v158, v159
    v_mfma_f32_16x16x32_bf16 v[184:187], a[240:243], v[40:43], v[184:187]
    ds_write_b32 v14, v156 offset:64
    v_mfma_f32_16x16x32_bf16 v[188:191], a[4:7], v[56:59], v[188:191]
    ds_write_b32 v14, v157 offset:68
    v_mfma_f32_16x16x32_bf16 v[188:191], a[16:19], v[60:63], v[188:191]
    v_mfma_f32_16x16x32_bf16 v[188:191], a[28:31], v[64:67], v[188:191]
    v_mfma_f32_16x16x32_bf16 v[188:191], a[112:115], v[68:71], v[188:191]
    v_mfma_f32_16x16x32_bf16 v[188:191], a[124:127], v[72:75], v[188:191]
    v_mfma_f32_16x16x32_bf16 v[188:191], a[136:139], v[76:79], v[188:191]
    v_mfma_f32_16x16x32_bf16 v[188:191], a[220:223], v[32:35], v[188:191]
    v_mfma_f32_16x16x32_bf16 v[188:191], a[232:235], v[36:39], v[188:191]
    v_mfma_f32_16x16x32_bf16 v[188:191], a[244:247], v[40:43], v[188:191]
    v_mfma_f32_16x16x32_bf16 v[192:195], a[8:11], v[56:59], v[192:195]
    v_mfma_f32_16x16x32_bf16 v[192:195], a[20:23], v[60:63], v[192:195]
    v_mfma_f32_16x16x32_bf16 v[192:195], a[32:35], v[64:67], v[192:195]
    v_mfma_f32_16x16x32_bf16 v[192:195], a[116:119], v[68:71], v[192:195]
    v_mfma_f32_16x16x32_bf16 v[192:195], a[128:131], v[72:75], v[192:195]
    v_mfma_f32_16x16x32_bf16 v[192:195], a[140:143], v[76:79], v[192:195]
    v_mfma_f32_16x16x32_bf16 v[192:195], a[224:227], v[32:35], v[192:195]
    v_mfma_f32_16x16x32_bf16 v[192:195], a[236:239], v[36:39], v[192:195]
    v_mfma_f32_16x16x32_bf16 v[192:195], a[248:251], v[40:43], v[192:195]
    ds_read_b128 v[56:59], v17 offset:0
    v_mfma_f32_16x16x32_bf16 v[160:163], a[36:39], v[68:71], v[160:163]
    ds_read_b128 v[60:63], v17 offset:64
    v_mfma_f32_16x16x32_bf16 v[160:163], a[48:51], v[72:75], v[160:163]
    ds_read_b128 v[64:67], v17 offset:128
    v_mfma_f32_16x16x32_bf16 v[160:163], a[60:63], v[76:79], v[160:163]
    v_mfma_f32_16x16x32_bf16 v[160:163], a[144:147], v[32:35], v[160:163]
    v_mfma_f32_16x16x32_bf16 v[160:163], a[156:159], v[36:39], v[160:163]
    v_mfma_f32_16x16x32_bf16 v[160:163], a[168:171], v[40:43], v[160:163]
    s_waitcnt lgkmcnt(3)
    v_mfma_f32_16x16x32_bf16 v[160:163], a[252:255], v[44:47], v[160:163]
    v_mfma_f32_16x16x32_bf16 v[160:163], v[88:91], v[48:51], v[160:163]
    v_mfma_f32_16x16x32_bf16 v[160:163], v[100:103], v[52:55], v[160:163]
    v_mfma_f32_16x16x32_bf16 v[164:167], a[40:43], v[68:71], v[164:167]
    v_mfma_f32_16x16x32_bf16 v[164:167], a[52:55], v[72:75], v[164:167]
    v_mfma_f32_16x16x32_bf16 v[164:167], a[64:67], v[76:79], v[164:167]
    v_mfma_f32_16x16x32_bf16 v[164:167], a[148:151], v[32:35], v[164:167]
    v_mfma_f32_16x16x32_bf16 v[164:167], a[160:163], v[36:39], v[164:167]
    v_mfma_f32_16x16x32_bf16 v[164:167], a[172:175], v[40:43], v[164:167]
    v_mfma_f32_16x16x32_bf16 v[164:167], v[80:83], v[44:47], v[164:167]
    v_mfma_f32_16x16x32_bf16 v[164:167], v[92:95], v[48:51], v[164:167]
    v_cvt_pk_bf16_f32 v160, v160, v161
    v_cvt_pk_bf16_f32 v161, v162, v163
    v_mfma_f32_16x16x32_bf16 v[164:167], v[104:107], v[52:55], v[164:167]
    ds_write_b32 v14, v160 offset:192
    v_mfma_f32_16x16x32_bf16 v[168:171], a[44:47], v[68:71], v[168:171]
    ds_write_b32 v14, v161 offset:196
    v_mfma_f32_16x16x32_bf16 v[168:171], a[56:59], v[72:75], v[168:171]
    v_mfma_f32_16x16x32_bf16 v[168:171], a[68:71], v[76:79], v[168:171]
    v_mfma_f32_16x16x32_bf16 v[168:171], a[152:155], v[32:35], v[168:171]
    v_mfma_f32_16x16x32_bf16 v[168:171], a[164:167], v[36:39], v[168:171]
    v_mfma_f32_16x16x32_bf16 v[168:171], a[176:179], v[40:43], v[168:171]
    v_mfma_f32_16x16x32_bf16 v[168:171], v[84:87], v[44:47], v[168:171]
    v_mfma_f32_16x16x32_bf16 v[168:171], v[96:99], v[48:51], v[168:171]
    v_cvt_pk_bf16_f32 v164, v164, v165
    v_cvt_pk_bf16_f32 v165, v166, v167
    v_mfma_f32_16x16x32_bf16 v[168:171], v[108:111], v[52:55], v[168:171]
    ds_write_b32 v15, v164 offset:192
    v_mfma_f32_16x16x32_bf16 v[196:199], a[0:3], v[68:71], v[196:199]
    ds_write_b32 v15, v165 offset:196
    v_mfma_f32_16x16x32_bf16 v[196:199], a[12:15], v[72:75], v[196:199]
    v_mfma_f32_16x16x32_bf16 v[196:199], a[24:27], v[76:79], v[196:199]
    v_mfma_f32_16x16x32_bf16 v[196:199], a[108:111], v[32:35], v[196:199]
    v_mfma_f32_16x16x32_bf16 v[196:199], a[120:123], v[36:39], v[196:199]
    v_mfma_f32_16x16x32_bf16 v[196:199], a[132:135], v[40:43], v[196:199]
    v_mfma_f32_16x16x32_bf16 v[196:199], a[216:219], v[44:47], v[196:199]
    v_mfma_f32_16x16x32_bf16 v[196:199], a[228:231], v[48:51], v[196:199]
    v_cvt_pk_bf16_f32 v168, v168, v169
    v_cvt_pk_bf16_f32 v169, v170, v171
    v_mfma_f32_16x16x32_bf16 v[196:199], a[240:243], v[52:55], v[196:199]
    ds_write_b32 v14, v168 offset:256
    v_mfma_f32_16x16x32_bf16 v[200:203], a[4:7], v[68:71], v[200:203]
    ds_write_b32 v14, v169 offset:260
    v_mfma_f32_16x16x32_bf16 v[200:203], a[16:19], v[72:75], v[200:203]
    v_mfma_f32_16x16x32_bf16 v[200:203], a[28:31], v[76:79], v[200:203]
    v_mfma_f32_16x16x32_bf16 v[200:203], a[112:115], v[32:35], v[200:203]
    v_mfma_f32_16x16x32_bf16 v[200:203], a[124:127], v[36:39], v[200:203]
    v_mfma_f32_16x16x32_bf16 v[200:203], a[136:139], v[40:43], v[200:203]
    v_mfma_f32_16x16x32_bf16 v[200:203], a[220:223], v[44:47], v[200:203]
    v_mfma_f32_16x16x32_bf16 v[200:203], a[232:235], v[48:51], v[200:203]
    v_mfma_f32_16x16x32_bf16 v[200:203], a[244:247], v[52:55], v[200:203]
    v_mfma_f32_16x16x32_bf16 v[204:207], a[8:11], v[68:71], v[204:207]
    v_mfma_f32_16x16x32_bf16 v[204:207], a[20:23], v[72:75], v[204:207]
    v_mfma_f32_16x16x32_bf16 v[204:207], a[32:35], v[76:79], v[204:207]
    v_mfma_f32_16x16x32_bf16 v[204:207], a[116:119], v[32:35], v[204:207]
    v_mfma_f32_16x16x32_bf16 v[204:207], a[128:131], v[36:39], v[204:207]
    v_mfma_f32_16x16x32_bf16 v[204:207], a[140:143], v[40:43], v[204:207]
    v_mfma_f32_16x16x32_bf16 v[204:207], a[224:227], v[44:47], v[204:207]
    v_mfma_f32_16x16x32_bf16 v[204:207], a[236:239], v[48:51], v[204:207]
    v_mfma_f32_16x16x32_bf16 v[204:207], a[248:251], v[52:55], v[204:207]
    v_mfma_f32_16x16x32_bf16 v[172:175], a[36:39], v[32:35], v[172:175]
    v_mfma_f32_16x16x32_bf16 v[172:175], a[48:51], v[36:39], v[172:175]
    v_mfma_f32_16x16x32_bf16 v[172:175], a[60:63], v[40:43], v[172:175]
    v_mfma_f32_16x16x32_bf16 v[172:175], a[144:147], v[44:47], v[172:175]
    v_mfma_f32_16x16x32_bf16 v[172:175], a[156:159], v[48:51], v[172:175]
    v_mfma_f32_16x16x32_bf16 v[172:175], a[168:171], v[52:55], v[172:175]
    s_waitcnt lgkmcnt(0)
    v_mfma_f32_16x16x32_bf16 v[172:175], a[252:255], v[56:59], v[172:175]
    v_mfma_f32_16x16x32_bf16 v[172:175], v[88:91], v[60:63], v[172:175]
    v_mfma_f32_16x16x32_bf16 v[172:175], v[100:103], v[64:67], v[172:175]
    v_mfma_f32_16x16x32_bf16 v[176:179], a[40:43], v[32:35], v[176:179]
    v_mfma_f32_16x16x32_bf16 v[176:179], a[52:55], v[36:39], v[176:179]
    v_mfma_f32_16x16x32_bf16 v[176:179], a[64:67], v[40:43], v[176:179]
    v_mfma_f32_16x16x32_bf16 v[176:179], a[148:151], v[44:47], v[176:179]
    s_waitcnt vmcnt(5)
    v_mfma_f32_16x16x32_bf16 v[176:179], a[160:163], v[48:51], v[176:179]
    s_barrier
    v_mfma_f32_16x16x32_bf16 v[176:179], a[172:175], v[52:55], v[176:179]
    ds_read_b128 v[168:171], v1 offset:48000
    v_mfma_f32_16x16x32_bf16 v[176:179], v[80:83], v[56:59], v[176:179]
    ds_read_b128 v[68:71], v1 offset:48064
    v_mfma_f32_16x16x32_bf16 v[176:179], v[92:95], v[60:63], v[176:179]
    v_cvt_pk_bf16_f32 v172, v172, v173
    v_cvt_pk_bf16_f32 v173, v174, v175
    v_mfma_f32_16x16x32_bf16 v[176:179], v[104:107], v[64:67], v[176:179]
    ds_write_b32 v14, v172 offset:384
    v_mfma_f32_16x16x32_bf16 v[180:183], a[44:47], v[32:35], v[180:183]
    ds_write_b32 v14, v173 offset:388
    v_mfma_f32_16x16x32_bf16 v[180:183], a[56:59], v[36:39], v[180:183]
    ds_read_b128 v[72:75], v1 offset:48128
    v_mfma_f32_16x16x32_bf16 v[180:183], a[68:71], v[40:43], v[180:183]
    ds_read_b128 v[76:79], v2 offset:48000
    v_mfma_f32_16x16x32_bf16 v[180:183], a[152:155], v[44:47], v[180:183]
    ds_read_b128 v[172:175], v2 offset:48064
    v_mfma_f32_16x16x32_bf16 v[180:183], a[164:167], v[48:51], v[180:183]
    v_mfma_f32_16x16x32_bf16 v[180:183], a[176:179], v[52:55], v[180:183]
    v_mfma_f32_16x16x32_bf16 v[180:183], v[84:87], v[56:59], v[180:183]
    v_mfma_f32_16x16x32_bf16 v[180:183], v[96:99], v[60:63], v[180:183]
    v_cvt_pk_bf16_f32 v176, v176, v177
    v_cvt_pk_bf16_f32 v177, v178, v179
    v_mfma_f32_16x16x32_bf16 v[180:183], v[108:111], v[64:67], v[180:183]
L_pad1:
    s_cbranch_vccnz L_padret
    ds_write_b32 v15, v176 offset:384
    v_mfma_f32_16x16x32_bf16 v[208:211], a[0:3], v[32:35], v[208:211]
    ds_write_b32 v15, v177 offset:388
    v_mfma_f32_16x16x32_bf16 v[208:211], a[12:15], v[36:39], v[208:211]
    v_mfma_f32_16x16x32_bf16 v[208:211], a[24:27], v[40:43], v[208:211]
    ds_read_b128 v[176:179], v2 offset:48128
    v_mfma_f32_16x16x32_bf16 v[208:211], a[108:111], v[44:47], v[208:211]
    v_mfma_f32_16x16x32_bf16 v[208:211], a[120:123], v[48:51], v[208:211]
    v_mfma_f32_16x16x32_bf16 v[208:211], a[132:135], v[52:55], v[208:211]
    v_mfma_f32_16x16x32_bf16 v[208:211], a[216:219], v[56:59], v[208:211]
    v_mfma_f32_16x16x32_bf16 v[208:211], a[228:231], v[60:63], v[208:211]
    v_cvt_pk_bf16_f32 v180, v180, v181
    v_cvt_pk_bf16_f32 v181, v182, v183
    v_mfma_f32_16x16x32_bf16 v[208:211], a[240:243], v[64:67], v[208:211]
    ds_write_b32 v14, v180 offset:448
    v_mfma_f32_16x16x32_bf16 v[212:215], a[4:7], v[32:35], v[212:215]
    ds_write_b32 v14, v181 offset:452
    v_mfma_f32_16x16x32_bf16 v[212:215], a[16:19], v[36:39], v[212:215]
    v_mfma_f32_16x16x32_bf16 v[212:215], a[28:31], v[40:43], v[212:215]
    ds_read_b128 v[180:183], v3 offset:48000
    v_mfma_f32_16x16x32_bf16 v[212:215], a[112:115], v[44:47], v[212:215]
    v_mfma_f32_16x16x32_bf16 v[212:215], a[124:127], v[48:51], v[212:215]
    v_mfma_f32_16x16x32_bf16 v[212:215], a[136:139], v[52:55], v[212:215]
    v_mfma_f32_16x16x32_bf16 v[212:215], a[220:223], v[56:59], v[212:215]
    v_mfma_f32_16x16x32_bf16 v[212:215], a[232:235], v[60:63], v[212:215]
    v_mfma_f32_16x16x32_bf16 v[212:215], a[244:247], v[64:67], v[212:215]
    v_mfma_f32_16x16x32_bf16 v[216:219], a[8:11], v[32:35], v[216:219]
    ds_read_b128 v[32:35], v3 offset:48064
    s_waitcnt lgkmcnt(2)
    v_mfma_f32_16x16x32_bf16 v[216:219], a[20:23], v[36:39], v[216:219]
    s_barrier
    v_mfma_f32_16x16x32_bf16 v[216:219], a[32:35], v[40:43], v[216:219]
    ds_read_b128 v[36:39], v3 offset:48128
    v_mfma_f32_16x16x32_bf16 v[216:219], a[116:119], v[44:47], v[216:219]
    ds_read_b128 v[148:151], v9 offset:0
    v_mfma_f32_16x16x32_bf16 v[216:219], a[128:131], v[48:51], v[216:219]
    ds_read_b128 v[152:155], v10 offset:0
    v_mfma_f32_16x16x32_bf16 v[216:219], a[140:143], v[52:55], v[216:219]
    ds_read_b128 v[156:159], v11 offset:0
    v_mfma_f32_16x16x32_bf16 v[216:219], a[224:227], v[56:59], v[216:219]
    ds_read_b128 v[160:163], v12 offset:0
    v_mfma_f32_16x16x32_bf16 v[216:219], a[236:239], v[60:63], v[216:219]
    ds_read_b128 v[164:167], v13 offset:0
    v_mfma_f32_16x16x32_bf16 v[216:219], a[248:251], v[64:67], v[216:219]
    v_mfma_f32_16x16x32_bf16 v[184:187], a[72:75], v[168:171], v[184:187]
    v_mfma_f32_16x16x32_bf16 v[184:187], a[84:87], v[68:71], v[184:187]
    v_mfma_f32_16x16x32_bf16 v[184:187], a[96:99], v[72:75], v[184:187]
    v_mfma_f32_16x16x32_bf16 v[184:187], a[180:183], v[76:79], v[184:187]
    v_mfma_f32_16x16x32_bf16 v[184:187], a[192:195], v[172:175], v[184:187]
    s_add_u32 s43, s20, 0
    v_mfma_f32_16x16x32_bf16 v[184:187], a[204:207], v[176:179], v[184:187]
    s_waitcnt lgkmcnt(4)
    buffer_store_dwordx4 v[148:151], v19, s[24:27], s43 offen offset:0 sc0 sc1
    v_mfma_f32_16x16x32_bf16 v[184:187], v[112:115], v[180:183], v[184:187]
    v_mfma_f32_16x16x32_bf16 v[184:187], v[124:127], v[32:35], v[184:187]
    v_mfma_f32_16x16x32_bf16 v[184:187], v[136:139], v[36:39], v[184:187]
    v_mfma_f32_16x16x32_bf16 v[188:191], a[76:79], v[168:171], v[188:191]
    v_mfma_f32_16x16x32_bf16 v[188:191], a[88:91], v[68:71], v[188:191]
    v_mfma_f32_16x16x32_bf16 v[188:191], a[100:103], v[72:75], v[188:191]
    v_mfma_f32_16x16x32_bf16 v[188:191], a[184:187], v[76:79], v[188:191]
    v_mfma_f32_16x16x32_bf16 v[188:191], a[196:199], v[172:175], v[188:191]
    v_mfma_f32_16x16x32_bf16 v[188:191], a[208:211], v[176:179], v[188:191]
    v_mfma_f32_16x16x32_bf16 v[188:191], v[116:119], v[180:183], v[188:191]
    v_mfma_f32_16x16x32_bf16 v[188:191], v[128:131], v[32:35], v[188:191]
    v_cvt_pk_bf16_f32 v184, v184, v185
    v_cvt_pk_bf16_f32 v185, v186, v187
    v_mfma_f32_16x16x32_bf16 v[188:191], v[140:143], v[36:39], v[188:191]
    ds_write_b32 v14, v184 offset:19200
    v_mfma_f32_16x16x32_bf16 v[192:195], a[80:83], v[168:171], v[192:195]
    ds_write_b32 v14, v185 offset:19204
    v_mfma_f32_16x16x32_bf16 v[192:195], a[92:95], v[68:71], v[192:195]
    v_mfma_f32_16x16x32_bf16 v[192:195], a[104:107], v[72:75], v[192:195]
    v_mfma_f32_16x16x32_bf16 v[192:195], a[188:191], v[76:79], v[192:195]
    v_mfma_f32_16x16x32_bf16 v[192:195], a[200:203], v[172:175], v[192:195]
    v_mfma_f32_16x16x32_bf16 v[192:195], a[212:215], v[176:179], v[192:195]
    s_waitcnt lgkmcnt(2)
    buffer_store_dwordx4 v[152:155], v19, s[24:27], s43 offen offset:1024 sc0 sc1
    v_mfma_f32_16x16x32_bf16 v[192:195], v[120:123], v[180:183], v[192:195]
    v_mfma_f32_16x16x32_bf16 v[192:195], v[132:135], v[32:35], v[192:195]
    v_cvt_pk_bf16_f32 v188, v188, v189
    v_cvt_pk_bf16_f32 v189, v190, v191
    v_mfma_f32_16x16x32_bf16 v[192:195], v[144:147], v[36:39], v[192:195]
    ds_write_b32 v15, v188 offset:19200
    v_mfma_f32_16x16x32_bf16 v[220:223], a[36:39], v[168:171], v[220:223]
    ds_write_b32 v15, v189 offset:19204
    v_mfma_f32_16x16x32_bf16 v[220:223], a[48:51], v[68:71], v[220:223]
    ds_read_b128 v[40:43], v16 offset:48000
    v_mfma_f32_16x16x32_bf16 v[220:223], a[60:63], v[72:75], v[220:223]
    ds_read_b128 v[44:47], v16 offset:48064
    v_mfma_f32_16x16x32_bf16 v[220:223], a[144:147], v[76:79], v[220:223]
    ds_read_b128 v[48:51], v16 offset:48128
    v_mfma_f32_16x16x32_bf16 v[220:223], a[156:159], v[172:175], v[220:223]
    v_mfma_f32_16x16x32_bf16 v[220:223], a[168:171], v[176:179], v[220:223]
    v_mfma_f32_16x16x32_bf16 v[220:223], a[252:255], v[180:183], v[220:223]
    v_mfma_f32_16x16x32_bf16 v[220:223], v[88:91], v[32:35], v[220:223]
    v_cvt_pk_bf16_f32 v192, v192, v193
    v_cvt_pk_bf16_f32 v193, v194, v195
    v_mfma_f32_16x16x32_bf16 v[220:223], v[100:103], v[36:39], v[220:223]
    ds_write_b32 v14, v192 offset:19264
    v_mfma_f32_16x16x32_bf16 v[224:227], a[40:43], v[168:171], v[224:227]
    ds_write_b32 v14, v193 offset:19268
    v_mfma_f32_16x16x32_bf16 v[224:227], a[52:55], v[68:71], v[224:227]
    v_mfma_f32_16x16x32_bf16 v[224:227], a[64:67], v[72:75], v[224:227]
    v_mfma_f32_16x16x32_bf16 v[224:227], a[148:151], v[76:79], v[224:227]
    v_mfma_f32_16x16x32_bf16 v[224:227], a[160:163], v[172:175], v[224:227]
    v_mfma_f32_16x16x32_bf16 v[224:227], a[172:175], v[176:179], v[224:227]
    buffer_store_dwordx4 v[156:159], v19, s[24:27], s43 offen offset:2048 sc0 sc1
    v_mfma_f32_16x16x32_bf16 v[224:227], v[80:83], v[180:183], v[224:227]
    v_mfma_f32_16x16x32_bf16 v[224:227], v[92:95], v[32:35], v[224:227]
    v_mfma_f32_16x16x32_bf16 v[224:227], v[104:107], v[36:39], v[224:227]
    v_mfma_f32_16x16x32_bf16 v[228:231], a[44:47], v[168:171], v[228:231]
    v_mfma_f32_16x16x32_bf16 v[228:231], a[56:59], v[68:71], v[228:231]
    v_mfma_f32_16x16x32_bf16 v[228:231], a[68:71], v[72:75], v[228:231]
    v_mfma_f32_16x16x32_bf16 v[228:231], a[152:155], v[76:79], v[228:231]
    v_mfma_f32_16x16x32_bf16 v[228:231], a[164:167], v[172:175], v[228:231]
    v_mfma_f32_16x16x32_bf16 v[228:231], a[176:179], v[176:179], v[228:231]
    v_mfma_f32_16x16x32_bf16 v[228:231], v[84:87], v[180:183], v[228:231]
    v_mfma_f32_16x16x32_bf16 v[228:231], v[96:99], v[32:35], v[228:231]
    v_mfma_f32_16x16x32_bf16 v[228:231], v[108:111], v[36:39], v[228:231]
    v_mfma_f32_16x16x32_bf16 v[184:187], a[0:3], v[168:171], v[20:23]
    v_mfma_f32_16x16x32_bf16 v[184:187], a[12:15], v[68:71], v[184:187]
    v_mfma_f32_16x16x32_bf16 v[184:187], a[24:27], v[72:75], v[184:187]
    v_mfma_f32_16x16x32_bf16 v[184:187], a[108:111], v[76:79], v[184:187]
    v_mfma_f32_16x16x32_bf16 v[184:187], a[120:123], v[172:175], v[184:187]
    v_mfma_f32_16x16x32_bf16 v[184:187], a[132:135], v[176:179], v[184:187]
    buffer_store_dwordx4 v[160:163], v19, s[24:27], s43 offen offset:3072 sc0 sc1
    v_mfma_f32_16x16x32_bf16 v[184:187], a[216:219], v[180:183], v[184:187]
    v_mfma_f32_16x16x32_bf16 v[184:187], a[228:231], v[32:35], v[184:187]
    v_mfma_f32_16x16x32_bf16 v[184:187], a[240:243], v[36:39], v[184:187]
    v_mfma_f32_16x16x32_bf16 v[188:191], a[4:7], v[168:171], v[24:27]
    v_mfma_f32_16x16x32_bf16 v[188:191], a[16:19], v[68:71], v[188:191]
    v_mfma_f32_16x16x32_bf16 v[188:191], a[28:31], v[72:75], v[188:191]
    v_mfma_f32_16x16x32_bf16 v[188:191], a[112:115], v[76:79], v[188:191]
    v_mfma_f32_16x16x32_bf16 v[188:191], a[124:127], v[172:175], v[188:191]
    v_mfma_f32_16x16x32_bf16 v[188:191], a[136:139], v[176:179], v[188:191]
    v_mfma_f32_16x16x32_bf16 v[188:191], a[220:223], v[180:183], v[188:191]
    v_mfma_f32_16x16x32_bf16 v[188:191], a[232:235], v[32:35], v[188:191]
    v_mfma_f32_16x16x32_bf16 v[188:191], a[244:247], v[36:39], v[188:191]
    v_mfma_f32_16x16x32_bf16 v[192:195], a[8:11], v[168:171], v[28:31]
    v_mfma_f32_16x16x32_bf16 v[192:195], a[20:23], v[68:71], v[192:195]
    s_add_u32 s46, s31, 368640
    s_add_u32 m0, s33, 96000
    v_mfma_f32_16x16x32_bf16 v[192:195], a[32:35], v[72:75], v[192:195]
    buffer_load_dwordx4 v4, s[12:15], s46 offen offset:0 nt lds
    v_mfma_f32_16x16x32_bf16 v[192:195], a[116:119], v[76:79], v[192:195]
    v_mfma_f32_16x16x32_bf16 v[192:195], a[128:131], v[172:175], v[192:195]
    v_mfma_f32_16x16x32_bf16 v[192:195], a[140:143], v[176:179], v[192:195]
    buffer_load_dwordx4 v5, s[12:15], s46 offen offset:2048 nt lds
    v_mfma_f32_16x16x32_bf16 v[192:195], a[224:227], v[180:183], v[192:195]
    s_mov_b32 exec_lo, 0
    buffer_store_dwordx4 v[164:167], v19, s[24:27], s43 offen offset:3584 sc0 sc1
    s_mov_b32 exec_lo, -1
    v_mfma_f32_16x16x32_bf16 v[192:195], a[236:239], v[32:35], v[192:195]
    v_mfma_f32_16x16x32_bf16 v[192:195], a[248:251], v[36:39], v[192:195]
    s_add_u32 m0, s33, 100096
    v_mfma_f32_16x16x32_bf16 v[196:199], a[72:75], v[76:79], v[196:199]
    buffer_load_dwordx4 v6, s[12:15], s46 offen offset:0 nt lds
    v_mfma_f32_16x16x32_bf16 v[196:199], a[84:87], v[172:175], v[196:199]
    v_mfma_f32_16x16x32_bf16 v[196:199], a[96:99], v[176:179], v[196:199]
    v_mfma_f32_16x16x32_bf16 v[196:199], a[180:183], v[180:183], v[196:199]
    buffer_load_dwordx4 v7, s[12:15], s46 offen offset:2048 nt lds
    v_mfma_f32_16x16x32_bf16 v[196:199], a[192:195], v[32:35], v[196:199]
    v_mfma_f32_16x16x32_bf16 v[196:199], a[204:207], v[36:39], v[196:199]
    s_waitcnt lgkmcnt(0)
    v_mfma_f32_16x16x32_bf16 v[196:199], v[112:115], v[40:43], v[196:199]
    buffer_load_dwordx4 v8, s[12:15], s46 offen offset:3456 nt lds
    v_mfma_f32_16x16x32_bf16 v[196:199], v[124:127], v[44:47], v[196:199]
    v_mfma_f32_16x16x32_bf16 v[196:199], v[136:139], v[48:51], v[196:199]
    v_mfma_f32_16x16x32_bf16 v[200:203], a[76:79], v[76:79], v[200:203]
    v_mfma_f32_16x16x32_bf16 v[200:203], a[88:91], v[172:175], v[200:203]
    v_mfma_f32_16x16x32_bf16 v[200:203], a[100:103], v[176:179], v[200:203]
    v_mfma_f32_16x16x32_bf16 v[200:203], a[184:187], v[180:183], v[200:203]
    v_mfma_f32_16x16x32_bf16 v[200:203], a[196:199], v[32:35], v[200:203]
    v_mfma_f32_16x16x32_bf16 v[200:203], a[208:211], v[36:39], v[200:203]
    v_mfma_f32_16x16x32_bf16 v[200:203], v[116:119], v[40:43], v[200:203]
    v_mfma_f32_16x16x32_bf16 v[200:203], v[128:131], v[44:47], v[200:203]
    v_cvt_pk_bf16_f32 v196, v196, v197
    v_cvt_pk_bf16_f32 v197, v198, v199
    v_mfma_f32_16x16x32_bf16 v[200:203], v[140:143], v[48:51], v[200:203]
    ds_write_b32 v14, v196 offset:19392
    v_mfma_f32_16x16x32_bf16 v[204:207], a[80:83], v[76:79], v[204:207]
    ds_write_b32 v14, v197 offset:19396
    v_mfma_f32_16x16x32_bf16 v[204:207], a[92:95], v[172:175], v[204:207]
    v_mfma_f32_16x16x32_bf16 v[204:207], a[104:107], v[176:179], v[204:207]
    v_mfma_f32_16x16x32_bf16 v[204:207], a[188:191], v[180:183], v[204:207]
    v_mfma_f32_16x16x32_bf16 v[204:207], a[200:203], v[32:35], v[204:207]
    v_mfma_f32_16x16x32_bf16 v[204:207], a[212:215], v[36:39], v[204:207]
    v_mfma_f32_16x16x32_bf16 v[204:207], v[120:123], v[40:43], v[204:207]
    v_mfma_f32_16x16x32_bf16 v[204:207], v[132:135], v[44:47], v[204:207]
    v_cvt_pk_bf16_f32 v200, v200, v201
    v_cvt_pk_bf16_f32 v201, v202, v203
    v_mfma_f32_16x16x32_bf16 v[204:207], v[144:147], v[48:51], v[204:207]
    ds_write_b32 v15, v200 offset:19392
    v_mfma_f32_16x16x32_bf16 v[232:235], a[36:39], v[76:79], v[232:235]
    ds_write_b32 v15, v201 offset:19396
    v_mfma_f32_16x16x32_bf16 v[232:235], a[48:51], v[172:175], v[232:235]
    ds_read_b128 v[52:55], v17 offset:48000
    v_mfma_f32_16x16x32_bf16 v[232:235], a[60:63], v[176:179], v[232:235]
    ds_read_b128 v[56:59], v17 offset:48064
    v_mfma_f32_16x16x32_bf16 v[232:235], a[144:147], v[180:183], v[232:235]
    ds_read_b128 v[60:63], v17 offset:48128
    v_mfma_f32_16x16x32_bf16 v[232:235], a[156:159], v[32:35], v[232:235]
    v_mfma_f32_16x16x32_bf16 v[232:235], a[168:171], v[36:39], v[232:235]
    v_mfma_f32_16x16x32_bf16 v[232:235], a[252:255], v[40:43], v[232:235]
    v_mfma_f32_16x16x32_bf16 v[232:235], v[88:91], v[44:47], v[232:235]
    v_cvt_pk_bf16_f32 v204, v204, v205
    v_cvt_pk_bf16_f32 v205, v206, v207
    v_mfma_f32_16x16x32_bf16 v[232:235], v[100:103], v[48:51], v[232:235]
    ds_write_b32 v14, v204 offset:19456
    v_mfma_f32_16x16x32_bf16 v[236:239], a[40:43], v[76:79], v[236:239]
    ds_write_b32 v14, v205 offset:19460
    v_mfma_f32_16x16x32_bf16 v[236:239], a[52:55], v[172:175], v[236:239]
    v_mfma_f32_16x16x32_bf16 v[236:239], a[64:67], v[176:179], v[236:239]
    v_mfma_f32_16x16x32_bf16 v[236:239], a[148:151], v[180:183], v[236:239]
    v_mfma_f32_16x16x32_bf16 v[236:239], a[160:163], v[32:35], v[236:239]
    v_mfma_f32_16x16x32_bf16 v[236:239], a[172:175], v[36:39], v[236:239]
    v_mfma_f32_16x16x32_bf16 v[236:239], v[80:83], v[40:43], v[236:239]
    v_mfma_f32_16x16x32_bf16 v[236:239], v[92:95], v[44:47], v[236:239]
    v_mfma_f32_16x16x32_bf16 v[236:239], v[104:107], v[48:51], v[236:239]
    v_mfma_f32_16x16x32_bf16 v[240:243], a[44:47], v[76:79], v[240:243]
    v_mfma_f32_16x16x32_bf16 v[240:243], a[56:59], v[172:175], v[240:243]
    v_mfma_f32_16x16x32_bf16 v[240:243], a[68:71], v[176:179], v[240:243]
    v_mfma_f32_16x16x32_bf16 v[240:243], a[152:155], v[180:183], v[240:243]
    v_mfma_f32_16x16x32_bf16 v[240:243], a[164:167], v[32:35], v[240:243]
    v_mfma_f32_16x16x32_bf16 v[240:243], a[176:179], v[36:39], v[240:243]
    v_mfma_f32_16x16x32_bf16 v[240:243], v[84:87], v[40:43], v[240:243]
    v_mfma_f32_16x16x32_bf16 v[240:243], v[96:99], v[44:47], v[240:243]
    v_mfma_f32_16x16x32_bf16 v[240:243], v[108:111], v[48:51], v[240:243]
    v_mfma_f32_16x16x32_bf16 v[196:199], a[0:3], v[76:79], v[20:23]
    v_mfma_f32_16x16x32_bf16 v[196:199], a[12:15], v[172:175], v[196:199]
    v_mfma_f32_16x16x32_bf16 v[196:199], a[24:27], v[176:179], v[196:199]
    v_mfma_f32_16x16x32_bf16 v[196:199], a[108:111], v[180:183], v[196:199]
    v_mfma_f32_16x16x32_bf16 v[196:199], a[120:123], v[32:35], v[196:199]
    v_mfma_f32_16x16x32_bf16 v[196:199], a[132:135], v[36:39], v[196:199]
    v_mfma_f32_16x16x32_bf16 v[196:199], a[216:219], v[40:43], v[196:199]
    v_mfma_f32_16x16x32_bf16 v[196:199], a[228:231], v[44:47], v[196:199]
    v_mfma_f32_16x16x32_bf16 v[196:199], a[240:243], v[48:51], v[196:199]
    v_mfma_f32_16x16x32_bf16 v[200:203], a[4:7], v[76:79], v[24:27]
    v_mfma_f32_16x16x32_bf16 v[200:203], a[16:19], v[172:175], v[200:203]
    v_mfma_f32_16x16x32_bf16 v[200:203], a[28:31], v[176:179], v[200:203]
    v_mfma_f32_16x16x32_bf16 v[200:203], a[112:115], v[180:183], v[200:203]
    v_mfma_f32_16x16x32_bf16 v[200:203], a[124:127], v[32:35], v[200:203]
    v_mfma_f32_16x16x32_bf16 v[200:203], a[136:139], v[36:39], v[200:203]
    v_mfma_f32_16x16x32_bf16 v[200:203], a[220:223], v[40:43], v[200:203]
    v_mfma_f32_16x16x32_bf16 v[200:203], a[232:235], v[44:47], v[200:203]
    v_mfma_f32_16x16x32_bf16 v[200:203], a[244:247], v[48:51], v[200:203]
    v_mfma_f32_16x16x32_bf16 v[204:207], a[8:11], v[76:79], v[28:31]
    v_mfma_f32_16x16x32_bf16 v[204:207], a[20:23], v[172:175], v[204:207]
    v_mfma_f32_16x16x32_bf16 v[204:207], a[32:35], v[176:179], v[204:207]
    v_mfma_f32_16x16x32_bf16 v[204:207], a[116:119], v[180:183], v[204:207]
    v_mfma_f32_16x16x32_bf16 v[204:207], a[128:131], v[32:35], v[204:207]
    v_mfma_f32_16x16x32_bf16 v[204:207], a[140:143], v[36:39], v[204:207]
    v_mfma_f32_16x16x32_bf16 v[204:207], a[224:227], v[40:43], v[204:207]
    v_mfma_f32_16x16x32_bf16 v[204:207], a[236:239], v[44:47], v[204:207]
    v_mfma_f32_16x16x32_bf16 v[204:207], a[248:251], v[48:51], v[204:207]
    v_mfma_f32_16x16x32_bf16 v[208:211], a[72:75], v[180:183], v[208:211]
    v_mfma_f32_16x16x32_bf16 v[208:211], a[84:87], v[32:35], v[208:211]
    v_mfma_f32_16x16x32_bf16 v[208:211], a[96:99], v[36:39], v[208:211]
    v_mfma_f32_16x16x32_bf16 v[208:211], a[180:183], v[40:43], v[208:211]
    v_mfma_f32_16x16x32_bf16 v[208:211], a[192:195], v[44:47], v[208:211]
    v_mfma_f32_16x16x32_bf16 v[208:211], a[204:207], v[48:51], v[208:211]
    s_waitcnt lgkmcnt(0)
    v_mfma_f32_16x16x32_bf16 v[208:211], v[112:115], v[52:55], v[208:211]
    v_mfma_f32_16x16x32_bf16 v[208:211], v[124:127], v[56:59], v[208:211]
    v_mfma_f32_16x16x32_bf16 v[208:211], v[136:139], v[60:63], v[208:211]
    v_mfma_f32_16x16x32_bf16 v[212:215], a[76:79], v[180:183], v[212:215]
    v_mfma_f32_16x16x32_bf16 v[212:215], a[88:91], v[32:35], v[212:215]
    v_mfma_f32_16x16x32_bf16 v[212:215], a[100:103], v[36:39], v[212:215]
    v_mfma_f32_16x16x32_bf16 v[212:215], a[184:187], v[40:43], v[212:215]
    v_mfma_f32_16x16x32_bf16 v[212:215], a[196:199], v[44:47], v[212:215]
    v_mfma_f32_16x16x32_bf16 v[212:215], a[208:211], v[48:51], v[212:215]
    v_mfma_f32_16x16x32_bf16 v[212:215], v[116:119], v[52:55], v[212:215]
    v_mfma_f32_16x16x32_bf16 v[212:215], v[128:131], v[56:59], v[212:215]
    v_cvt_pk_bf16_f32 v208, v208, v209
    v_cvt_pk_bf16_f32 v209, v210, v211
    v_mfma_f32_16x16x32_bf16 v[212:215], v[140:143], v[60:63], v[212:215]
    ds_write_b32 v14, v208 offset:19584
    v_mfma_f32_16x16x32_bf16 v[216:219], a[80:83], v[180:183], v[216:219]
    ds_write_b32 v14, v209 offset:19588
    v_mfma_f32_16x16x32_bf16 v[216:219], a[92:95], v[32:35], v[216:219]
    v_mfma_f32_16x16x32_bf16 v[216:219], a[104:107], v[36:39], v[216:219]
    v_mfma_f32_16x16x32_bf16 v[216:219], a[188:191], v[40:43], v[216:219]
    v_mfma_f32_16x16x32_bf16 v[216:219], a[200:203], v[44:47], v[216:219]
    v_mfma_f32_16x16x32_bf16 v[216:219], a[212:215], v[48:51], v[216:219]
    v_mfma_f32_16x16x32_bf16 v[216:219], v[120:123], v[52:55], v[216:219]
    v_mfma_f32_16x16x32_bf16 v[216:219], v[132:135], v[56:59], v[216:219]
    v_cvt_pk_bf16_f32 v212, v212, v213
    v_cvt_pk_bf16_f32 v213, v214, v215
    v_mfma_f32_16x16x32_bf16 v[216:219], v[144:147], v[60:63], v[216:219]
    ds_write_b32 v15, v212 offset:19584
    v_mfma_f32_16x16x32_bf16 v[244:247], a[36:39], v[180:183], v[244:247]
    ds_write_b32 v15, v213 offset:19588
    v_mfma_f32_16x16x32_bf16 v[244:247], a[48:51], v[32:35], v[244:247]
    v_mfma_f32_16x16x32_bf16 v[244:247], a[60:63], v[36:39], v[244:247]
    v_mfma_f32_16x16x32_bf16 v[244:247], a[144:147], v[40:43], v[244:247]
    v_mfma_f32_16x16x32_bf16 v[244:247], a[156:159], v[44:47], v[244:247]
    v_mfma_f32_16x16x32_bf16 v[244:247], a[168:171], v[48:51], v[244:247]
    v_mfma_f32_16x16x32_bf16 v[244:247], a[252:255], v[52:55], v[244:247]
    v_mfma_f32_16x16x32_bf16 v[244:247], v[88:91], v[56:59], v[244:247]
    v_cvt_pk_bf16_f32 v216, v216, v217
    v_cvt_pk_bf16_f32 v217, v218, v219
    v_mfma_f32_16x16x32_bf16 v[244:247], v[100:103], v[60:63], v[244:247]
    ds_write_b32 v14, v216 offset:19648
    v_mfma_f32_16x16x32_bf16 v[248:251], a[40:43], v[180:183], v[248:251]
    ds_write_b32 v14, v217 offset:19652
    v_mfma_f32_16x16x32_bf16 v[248:251], a[52:55], v[32:35], v[248:251]
    v_mfma_f32_16x16x32_bf16 v[248:251], a[64:67], v[36:39], v[248:251]
    v_add_u32 v1, 0x10680, v1
    v_add_u32 v2, 0x10680, v2
    v_add_u32 v3, 0x10680, v3
    v_mfma_f32_16x16x32_bf16 v[248:251], a[148:151], v[40:43], v[248:251]
    v_add_u32 v16, 0x10680, v16
    v_add_u32 v17, 0x10680, v17
    v_mfma_f32_16x16x32_bf16 v[248:251], a[160:163], v[44:47], v[248:251]
    v_mfma_f32_16x16x32_bf16 v[248:251], a[172:175], v[48:51], v[248:251]
    v_mfma_f32_16x16x32_bf16 v[248:251], v[80:83], v[52:55], v[248:251]
    v_mfma_f32_16x16x32_bf16 v[248:251], v[92:95], v[56:59], v[248:251]
    v_mfma_f32_16x16x32_bf16 v[248:251], v[104:107], v[60:63], v[248:251]
    v_mfma_f32_16x16x32_bf16 v[252:255], a[44:47], v[180:183], v[252:255]
    s_waitcnt vmcnt(10) lgkmcnt(0)
    v_mfma_f32_16x16x32_bf16 v[252:255], a[56:59], v[32:35], v[252:255]
    s_barrier
    v_mfma_f32_16x16x32_bf16 v[252:255], a[68:71], v[36:39], v[252:255]
    ds_read_b128 v[64:67], v1 offset:0
    v_mfma_f32_16x16x32_bf16 v[252:255], a[152:155], v[40:43], v[252:255]
    ds_read_b128 v[168:171], v1 offset:64
    v_mfma_f32_16x16x32_bf16 v[252:255], a[164:167], v[44:47], v[252:255]
    ds_read_b128 v[68:71], v1 offset:128
    v_mfma_f32_16x16x32_bf16 v[252:255], a[176:179], v[48:51], v[252:255]
    ds_read_b128 v[72:75], v2 offset:0
    v_mfma_f32_16x16x32_bf16 v[252:255], v[84:87], v[52:55], v[252:255]
    ds_read_b128 v[76:79], v2 offset:64
    v_mfma_f32_16x16x32_bf16 v[252:255], v[96:99], v[56:59], v[252:255]
    ds_read_b128 v[172:175], v2 offset:128
    v_mfma_f32_16x16x32_bf16 v[252:255], v[108:111], v[60:63], v[252:255]
    ds_read_b128 v[176:179], v3 offset:0
    v_mfma_f32_16x16x32_bf16 v[208:211], a[0:3], v[180:183], v[20:23]
    ds_read_b128 v[148:151], v9 offset:19200
    v_mfma_f32_16x16x32_bf16 v[208:211], a[12:15], v[32:35], v[208:211]
    ds_read_b128 v[152:155], v10 offset:19200
    v_mfma_f32_16x16x32_bf16 v[208:211], a[24:27], v[36:39], v[208:211]
    ds_read_b128 v[156:159], v11 offset:19200
    v_mfma_f32_16x16x32_bf16 v[208:211], a[108:111], v[40:43], v[208:211]
    ds_read_b128 v[160:163], v12 offset:19200
    v_mfma_f32_16x16x32_bf16 v[208:211], a[120:123], v[44:47], v[208:211]
    ds_read_b128 v[164:167], v13 offset:19200
    v_mfma_f32_16x16x32_bf16 v[208:211], a[132:135], v[48:51], v[208:211]
    v_mfma_f32_16x16x32_bf16 v[208:211], a[216:219], v[52:55], v[208:211]
    v_mfma_f32_16x16x32_bf16 v[208:211], a[228:231], v[56:59], v[208:211]
    v_mfma_f32_16x16x32_bf16 v[208:211], a[240:243], v[60:63], v[208:211]
    v_mfma_f32_16x16x32_bf16 v[212:215], a[4:7], v[180:183], v[24:27]
    v_mfma_f32_16x16x32_bf16 v[212:215], a[16:19], v[32:35], v[212:215]
    s_add_u32 s43, s20, 73728
    v_mfma_f32_16x16x32_bf16 v[212:215], a[28:31], v[36:39], v[212:215]
    s_waitcnt lgkmcnt(4)
    buffer_store_dwordx4 v[148:151], v19, s[24:27], s43 offen offset:0 sc0 sc1
    v_mfma_f32_16x16x32_bf16 v[212:215], a[112:115], v[40:43], v[212:215]
    v_mfma_f32_16x16x32_bf16 v[212:215], a[124:127], v[44:47], v[212:215]
    v_mfma_f32_16x16x32_bf16 v[212:215], a[136:139], v[48:51], v[212:215]
    v_mfma_f32_16x16x32_bf16 v[212:215], a[220:223], v[52:55], v[212:215]
    v_mfma_f32_16x16x32_bf16 v[212:215], a[232:235], v[56:59], v[212:215]
    v_mfma_f32_16x16x32_bf16 v[212:215], a[244:247], v[60:63], v[212:215]
    v_mfma_f32_16x16x32_bf16 v[216:219], a[8:11], v[180:183], v[28:31]
    ds_read_b128 v[180:183], v3 offset:64
    v_mfma_f32_16x16x32_bf16 v[216:219], a[20:23], v[32:35], v[216:219]
    ds_read_b128 v[32:35], v3 offset:128
    v_mfma_f32_16x16x32_bf16 v[216:219], a[32:35], v[36:39], v[216:219]
    v_mfma_f32_16x16x32_bf16 v[216:219], a[116:119], v[40:43], v[216:219]
    v_mfma_f32_16x16x32_bf16 v[216:219], a[128:131], v[44:47], v[216:219]
    v_mfma_f32_16x16x32_bf16 v[216:219], a[140:143], v[48:51], v[216:219]
    v_mfma_f32_16x16x32_bf16 v[216:219], a[224:227], v[52:55], v[216:219]
    v_mfma_f32_16x16x32_bf16 v[216:219], a[236:239], v[56:59], v[216:219]
    v_mfma_f32_16x16x32_bf16 v[216:219], a[248:251], v[60:63], v[216:219]
    v_mfma_f32_16x16x32_bf16 v[220:223], a[72:75], v[64:67], v[220:223]
    v_mfma_f32_16x16x32_bf16 v[220:223], a[84:87], v[168:171], v[220:223]
    v_mfma_f32_16x16x32_bf16 v[220:223], a[96:99], v[68:71], v[220:223]
    v_mfma_f32_16x16x32_bf16 v[220:223], a[180:183], v[72:75], v[220:223]
    v_mfma_f32_16x16x32_bf16 v[220:223], a[192:195], v[76:79], v[220:223]
    s_waitcnt lgkmcnt(0)
    buffer_store_dwordx4 v[152:155], v19, s[24:27], s43 offen offset:1024 sc0 sc1
    v_mfma_f32_16x16x32_bf16 v[220:223], a[204:207], v[172:175], v[220:223]
    v_mfma_f32_16x16x32_bf16 v[220:223], v[112:115], v[176:179], v[220:223]
    v_mfma_f32_16x16x32_bf16 v[220:223], v[124:127], v[180:183], v[220:223]
    v_mfma_f32_16x16x32_bf16 v[220:223], v[136:139], v[32:35], v[220:223]
    v_mfma_f32_16x16x32_bf16 v[224:227], a[76:79], v[64:67], v[224:227]
    v_mfma_f32_16x16x32_bf16 v[224:227], a[88:91], v[168:171], v[224:227]
    v_mfma_f32_16x16x32_bf16 v[224:227], a[100:103], v[68:71], v[224:227]
    v_mfma_f32_16x16x32_bf16 v[224:227], a[184:187], v[72:75], v[224:227]
    v_mfma_f32_16x16x32_bf16 v[224:227], a[196:199], v[76:79], v[224:227]
    v_mfma_f32_16x16x32_bf16 v[224:227], a[208:211], v[172:175], v[224:227]
    v_mfma_f32_16x16x32_bf16 v[224:227], v[116:119], v[176:179], v[224:227]
    v_mfma_f32_16x16x32_bf16 v[224:227], v[128:131], v[180:183], v[224:227]
    v_cvt_pk_bf16_f32 v220, v220, v221
    v_cvt_pk_bf16_f32 v221, v222, v223
    v_mfma_f32_16x16x32_bf16 v[224:227], v[140:143], v[32:35], v[224:227]
    ds_write_b32 v14, v220 offset:0
    v_mfma_f32_16x16x32_bf16 v[228:231], a[80:83], v[64:67], v[228:231]
    ds_write_b32 v14, v221 offset:4
    v_mfma_f32_16x16x32_bf16 v[228:231], a[92:95], v[168:171], v[228:231]
    v_mfma_f32_16x16x32_bf16 v[228:231], a[104:107], v[68:71], v[228:231]
    v_mfma_f32_16x16x32_bf16 v[228:231], a[188:191], v[72:75], v[228:231]
    v_mfma_f32_16x16x32_bf16 v[228:231], a[200:203], v[76:79], v[228:231]
    v_mfma_f32_16x16x32_bf16 v[228:231], a[212:215], v[172:175], v[228:231]
    v_mfma_f32_16x16x32_bf16 v[228:231], v[120:123], v[176:179], v[228:231]
    buffer_store_dwordx4 v[156:159], v19, s[24:27], s43 offen offset:2048 sc0 sc1
    v_mfma_f32_16x16x32_bf16 v[228:231], v[132:135], v[180:183], v[228:231]
    v_cvt_pk_bf16_f32 v224, v224, v225
    v_cvt_pk_bf16_f32 v225, v226, v227
    v_mfma_f32_16x16x32_bf16 v[228:231], v[144:147], v[32:35], v[228:231]
    ds_write_b32 v15, v224 offset:0
    v_mfma_f32_16x16x32_bf16 v[184:187], a[36:39], v[64:67], v[184:187]
    ds_write_b32 v15, v225 offset:4
    v_mfma_f32_16x16x32_bf16 v[184:187], a[48:51], v[168:171], v[184:187]
    ds_read_b128 v[36:39], v16 offset:0
    v_mfma_f32_16x16x32_bf16 v[184:187], a[60:63], v[68:71], v[184:187]
    ds_read_b128 v[40:43], v16 offset:64
    v_mfma_f32_16x16x32_bf16 v[184:187], a[144:147], v[72:75], v[184:187]
    ds_read_b128 v[44:47], v16 offset:128
    v_mfma_f32_16x16x32_bf16 v[184:187], a[156:159], v[76:79], v[184:187]
    v_mfma_f32_16x16x32_bf16 v[184:187], a[168:171], v[172:175], v[184:187]
    v_mfma_f32_16x16x32_bf16 v[184:187], a[252:255], v[176:179], v[184:187]
    v_mfma_f32_16x16x32_bf16 v[184:187], v[88:91], v[180:183], v[184:187]
    v_cvt_pk_bf16_f32 v228, v228, v229
    v_cvt_pk_bf16_f32 v229, v230, v231
    v_mfma_f32_16x16x32_bf16 v[184:187], v[100:103], v[32:35], v[184:187]
    ds_write_b32 v14, v228 offset:64
    v_mfma_f32_16x16x32_bf16 v[188:191], a[40:43], v[64:67], v[188:191]
    ds_write_b32 v14, v229 offset:68
    v_mfma_f32_16x16x32_bf16 v[188:191], a[52:55], v[168:171], v[188:191]
    v_mfma_f32_16x16x32_bf16 v[188:191], a[64:67], v[68:71], v[188:191]
    v_mfma_f32_16x16x32_bf16 v[188:191], a[148:151], v[72:75], v[188:191]
    v_mfma_f32_16x16x32_bf16 v[188:191], a[160:163], v[76:79], v[188:191]
    v_mfma_f32_16x16x32_bf16 v[188:191], a[172:175], v[172:175], v[188:191]
    v_mfma_f32_16x16x32_bf16 v[188:191], v[80:83], v[176:179], v[188:191]
    v_mfma_f32_16x16x32_bf16 v[188:191], v[92:95], v[180:183], v[188:191]
    v_mfma_f32_16x16x32_bf16 v[188:191], v[104:107], v[32:35], v[188:191]
    buffer_store_dwordx4 v[160:163], v19, s[24:27], s43 offen offset:3072 sc0 sc1
    v_mfma_f32_16x16x32_bf16 v[192:195], a[44:47], v[64:67], v[192:195]
    v_mfma_f32_16x16x32_bf16 v[192:195], a[56:59], v[168:171], v[192:195]
    v_mfma_f32_16x16x32_bf16 v[192:195], a[68:71], v[68:71], v[192:195]
    v_mfma_f32_16x16x32_bf16 v[192:195], a[152:155], v[72:75], v[192:195]
    v_mfma_f32_16x16x32_bf16 v[192:195], a[164:167], v[76:79], v[192:195]
    v_mfma_f32_16x16x32_bf16 v[192:195], a[176:179], v[172:175], v[192:195]
    s_mul_i32 s46, s30, 73728
    s_add_u32 s46, s32, s46
    s_add_u32 s46, s46, 884736
    v_mfma_f32_16x16x32_bf16 v[192:195], v[84:87], v[176:179], v[192:195]
    s_mul_i32 s36, s30, 19200
    s_add_u32 s33, s33, s36
    s_add_u32 m0, s33, 57600
    v_mfma_f32_16x16x32_bf16 v[192:195], v[96:99], v[180:183], v[192:195]
    buffer_load_dwordx4 v4, s[12:15], s46 offen offset:0 nt lds
    v_mfma_f32_16x16x32_bf16 v[192:195], v[108:111], v[32:35], v[192:195]
    v_mfma_f32_16x16x32_bf16 v[220:223], a[0:3], v[64:67], v[20:23]
    v_mfma_f32_16x16x32_bf16 v[220:223], a[12:15], v[168:171], v[220:223]
    buffer_load_dwordx4 v5, s[12:15], s46 offen offset:2048 nt lds
    v_mfma_f32_16x16x32_bf16 v[220:223], a[24:27], v[68:71], v[220:223]
    v_mfma_f32_16x16x32_bf16 v[220:223], a[108:111], v[72:75], v[220:223]
    v_mfma_f32_16x16x32_bf16 v[220:223], a[120:123], v[76:79], v[220:223]
    s_add_u32 m0, s33, 61696
    v_mfma_f32_16x16x32_bf16 v[220:223], a[132:135], v[172:175], v[220:223]
    buffer_load_dwordx4 v6, s[12:15], s46 offen offset:0 nt lds
    v_mfma_f32_16x16x32_bf16 v[220:223], a[216:219], v[176:179], v[220:223]
    v_mfma_f32_16x16x32_bf16 v[220:223], a[228:231], v[180:183], v[220:223]
    v_mfma_f32_16x16x32_bf16 v[220:223], a[240:243], v[32:35], v[220:223]
    buffer_load_dwordx4 v7, s[12:15], s46 offen offset:2048 nt lds
    v_mfma_f32_16x16x32_bf16 v[224:227], a[4:7], v[64:67], v[24:27]
    v_mfma_f32_16x16x32_bf16 v[224:227], a[16:19], v[168:171], v[224:227]
    s_mov_b32 exec_lo, 0
    buffer_store_dwordx4 v[164:167], v19, s[24:27], s43 offen offset:3584 sc0 sc1
    s_mov_b32 exec_lo, -1
    v_mfma_f32_16x16x32_bf16 v[224:227], a[28:31], v[68:71], v[224:227]
    buffer_load_dwordx4 v8, s[12:15], s46 offen offset:3456 nt lds
    v_mfma_f32_16x16x32_bf16 v[224:227], a[112:115], v[72:75], v[224:227]
    v_mfma_f32_16x16x32_bf16 v[224:227], a[124:127], v[76:79], v[224:227]
    v_mfma_f32_16x16x32_bf16 v[224:227], a[136:139], v[172:175], v[224:227]
    v_mfma_f32_16x16x32_bf16 v[224:227], a[220:223], v[176:179], v[224:227]
    s_movk_i32 s37, 192
    v_mfma_f32_16x16x32_bf16 v[224:227], a[232:235], v[180:183], v[224:227]
    s_mul_i32 s38, s30, 9600
    v_mfma_f32_16x16x32_bf16 v[224:227], a[244:247], v[32:35], v[224:227]
    s_add_u32 s38, s38, 48000
    v_mfma_f32_16x16x32_bf16 v[228:231], a[8:11], v[64:67], v[28:31]
    v_lshrrev_b32 v7, 4, v0
    v_mfma_f32_16x16x32_bf16 v[228:231], a[20:23], v[168:171], v[228:231]
    v_and_b32 v18, 15, v0
    v_mfma_f32_16x16x32_bf16 v[228:231], a[32:35], v[68:71], v[228:231]
    v_add_u32 v18, 0, v18
    v_mfma_f32_16x16x32_bf16 v[228:231], a[116:119], v[72:75], v[228:231]
    v_lshrrev_b32 v8, 1, v18
    v_mfma_f32_16x16x32_bf16 v[228:231], a[128:131], v[76:79], v[228:231]
    v_and_b32 v8, 2, v8
    v_mfma_f32_16x16x32_bf16 v[228:231], a[140:143], v[172:175], v[228:231]
    v_xor_b32 v8, v8, v7
    v_mfma_f32_16x16x32_bf16 v[228:231], a[224:227], v[176:179], v[228:231]
    v_lshlrev_b32 v8, 4, v8
    v_mfma_f32_16x16x32_bf16 v[228:231], a[236:239], v[180:183], v[228:231]
    v_mad_u32_u24 v8, v18, s37, v8
    v_mfma_f32_16x16x32_bf16 v[228:231], a[248:251], v[32:35], v[228:231]
    v_add_u32 v4, s38, v8
    v_mfma_f32_16x16x32_bf16 v[232:235], a[72:75], v[72:75], v[232:235]
    v_and_b32 v18, 15, v0
    v_mfma_f32_16x16x32_bf16 v[232:235], a[84:87], v[76:79], v[232:235]
    v_add_u32 v18, 1, v18
    v_mfma_f32_16x16x32_bf16 v[232:235], a[96:99], v[172:175], v[232:235]
    v_lshrrev_b32 v8, 1, v18
    v_mfma_f32_16x16x32_bf16 v[232:235], a[180:183], v[176:179], v[232:235]
    v_and_b32 v8, 2, v8
    v_mfma_f32_16x16x32_bf16 v[232:235], a[192:195], v[180:183], v[232:235]
    v_xor_b32 v8, v8, v7
    v_mfma_f32_16x16x32_bf16 v[232:235], a[204:207], v[32:35], v[232:235]
    v_lshlrev_b32 v8, 4, v8
    s_waitcnt lgkmcnt(0)
    v_mfma_f32_16x16x32_bf16 v[232:235], v[112:115], v[36:39], v[232:235]
    v_mad_u32_u24 v8, v18, s37, v8
    v_mfma_f32_16x16x32_bf16 v[232:235], v[124:127], v[40:43], v[232:235]
    v_add_u32 v5, s38, v8
    v_mfma_f32_16x16x32_bf16 v[232:235], v[136:139], v[44:47], v[232:235]
    v_and_b32 v18, 15, v0
    v_mfma_f32_16x16x32_bf16 v[236:239], a[76:79], v[72:75], v[236:239]
    v_add_u32 v18, 2, v18
    v_mfma_f32_16x16x32_bf16 v[236:239], a[88:91], v[76:79], v[236:239]
    v_lshrrev_b32 v8, 1, v18
    v_mfma_f32_16x16x32_bf16 v[236:239], a[100:103], v[172:175], v[236:239]
    v_and_b32 v8, 2, v8
    v_mfma_f32_16x16x32_bf16 v[236:239], a[184:187], v[176:179], v[236:239]
    v_xor_b32 v8, v8, v7
    v_mfma_f32_16x16x32_bf16 v[236:239], a[196:199], v[180:183], v[236:239]
    v_lshlrev_b32 v8, 4, v8
    v_mfma_f32_16x16x32_bf16 v[236:239], a[208:211], v[32:35], v[236:239]
    v_mad_u32_u24 v8, v18, s37, v8
    v_mfma_f32_16x16x32_bf16 v[236:239], v[116:119], v[36:39], v[236:239]
L_pad2:
    s_cbranch_vccnz L_padret
    v_add_u32 v6, s38, v8
    v_mfma_f32_16x16x32_bf16 v[236:239], v[128:131], v[40:43], v[236:239]
    v_cvt_pk_bf16_f32 v232, v232, v233
    v_cvt_pk_bf16_f32 v233, v234, v235
    v_mfma_f32_16x16x32_bf16 v[236:239], v[140:143], v[44:47], v[236:239]
    ds_write_b32 v14, v232 offset:192
    v_mfma_f32_16x16x32_bf16 v[240:243], a[80:83], v[72:75], v[240:243]
    ds_write_b32 v14, v233 offset:196
    v_mfma_f32_16x16x32_bf16 v[240:243], a[92:95], v[76:79], v[240:243]
    v_mfma_f32_16x16x32_bf16 v[240:243], a[104:107], v[172:175], v[240:243]
    v_mfma_f32_16x16x32_bf16 v[240:243], a[188:191], v[176:179], v[240:243]
    v_mfma_f32_16x16x32_bf16 v[240:243], a[200:203], v[180:183], v[240:243]
    v_mfma_f32_16x16x32_bf16 v[240:243], a[212:215], v[32:35], v[240:243]
    v_mfma_f32_16x16x32_bf16 v[240:243], v[120:123], v[36:39], v[240:243]
    v_mfma_f32_16x16x32_bf16 v[240:243], v[132:135], v[40:43], v[240:243]
    v_cvt_pk_bf16_f32 v236, v236, v237
    v_cvt_pk_bf16_f32 v237, v238, v239
    v_mfma_f32_16x16x32_bf16 v[240:243], v[144:147], v[44:47], v[240:243]
    ds_write_b32 v15, v236 offset:192
    v_mfma_f32_16x16x32_bf16 v[196:199], a[36:39], v[72:75], v[196:199]
    ds_write_b32 v15, v237 offset:196
    v_mfma_f32_16x16x32_bf16 v[196:199], a[48:51], v[76:79], v[196:199]
    ds_read_b128 v[48:51], v17 offset:0
    v_mfma_f32_16x16x32_bf16 v[196:199], a[60:63], v[172:175], v[196:199]
    ds_read_b128 v[52:55], v17 offset:64
    v_mfma_f32_16x16x32_bf16 v[196:199], a[144:147], v[176:179], v[196:199]
    ds_read_b128 v[56:59], v17 offset:128
    v_mfma_f32_16x16x32_bf16 v[196:199], a[156:159], v[180:183], v[196:199]
    v_mfma_f32_16x16x32_bf16 v[196:199], a[168:171], v[32:35], v[196:199]
    v_mfma_f32_16x16x32_bf16 v[196:199], a[252:255], v[36:39], v[196:199]
    v_mfma_f32_16x16x32_bf16 v[196:199], v[88:91], v[40:43], v[196:199]
    v_cvt_pk_bf16_f32 v240, v240, v241
    v_cvt_pk_bf16_f32 v241, v242, v243
    v_mfma_f32_16x16x32_bf16 v[196:199], v[100:103], v[44:47], v[196:199]
    ds_write_b32 v14, v240 offset:256
    v_mfma_f32_16x16x32_bf16 v[200:203], a[40:43], v[72:75], v[200:203]
    ds_write_b32 v14, v241 offset:260
    v_mfma_f32_16x16x32_bf16 v[200:203], a[52:55], v[76:79], v[200:203]
    v_mfma_f32_16x16x32_bf16 v[200:203], a[64:67], v[172:175], v[200:203]
    v_mfma_f32_16x16x32_bf16 v[200:203], a[148:151], v[176:179], v[200:203]
    v_mfma_f32_16x16x32_bf16 v[200:203], a[160:163], v[180:183], v[200:203]
    v_mfma_f32_16x16x32_bf16 v[200:203], a[172:175], v[32:35], v[200:203]
    v_mfma_f32_16x16x32_bf16 v[200:203], v[80:83], v[36:39], v[200:203]
    v_mfma_f32_16x16x32_bf16 v[200:203], v[92:95], v[40:43], v[200:203]
    v_mfma_f32_16x16x32_bf16 v[200:203], v[104:107], v[44:47], v[200:203]
    v_mfma_f32_16x16x32_bf16 v[204:207], a[44:47], v[72:75], v[204:207]
    v_mfma_f32_16x16x32_bf16 v[204:207], a[56:59], v[76:79], v[204:207]
    v_mfma_f32_16x16x32_bf16 v[204:207], a[68:71], v[172:175], v[204:207]
    v_mfma_f32_16x16x32_bf16 v[204:207], a[152:155], v[176:179], v[204:207]
    v_mfma_f32_16x16x32_bf16 v[204:207], a[164:167], v[180:183], v[204:207]
    v_mfma_f32_16x16x32_bf16 v[204:207], a[176:179], v[32:35], v[204:207]
    v_mfma_f32_16x16x32_bf16 v[204:207], v[84:87], v[36:39], v[204:207]
    v_mfma_f32_16x16x32_bf16 v[204:207], v[96:99], v[40:43], v[204:207]
    v_mfma_f32_16x16x32_bf16 v[204:207], v[108:111], v[44:47], v[204:207]
    v_mfma_f32_16x16x32_bf16 v[232:235], a[0:3], v[72:75], v[20:23]
    v_mfma_f32_16x16x32_bf16 v[232:235], a[12:15], v[76:79], v[232:235]
    v_mfma_f32_16x16x32_bf16 v[232:235], a[24:27], v[172:175], v[232:235]
    v_mfma_f32_16x16x32_bf16 v[232:235], a[108:111], v[176:179], v[232:235]
    v_mfma_f32_16x16x32_bf16 v[232:235], a[120:123], v[180:183], v[232:235]
    v_mfma_f32_16x16x32_bf16 v[232:235], a[132:135], v[32:35], v[232:235]
    v_mfma_f32_16x16x32_bf16 v[232:235], a[216:219], v[36:39], v[232:235]
    v_mfma_f32_16x16x32_bf16 v[232:235], a[228:231], v[40:43], v[232:235]
    v_mfma_f32_16x16x32_bf16 v[232:235], a[240:243], v[44:47], v[232:235]
    v_mfma_f32_16x16x32_bf16 v[236:239], a[4:7], v[72:75], v[24:27]
    v_mfma_f32_16x16x32_bf16 v[236:239], a[16:19], v[76:79], v[236:239]
    v_mfma_f32_16x16x32_bf16 v[236:239], a[28:31], v[172:175], v[236:239]
    v_mfma_f32_16x16x32_bf16 v[236:239], a[112:115], v[176:179], v[236:239]
    v_mfma_f32_16x16x32_bf16 v[236:239], a[124:127], v[180:183], v[236:239]
    v_mfma_f32_16x16x32_bf16 v[236:239], a[136:139], v[32:35], v[236:239]
    v_mfma_f32_16x16x32_bf16 v[236:239], a[220:223], v[36:39], v[236:239]
    v_mfma_f32_16x16x32_bf16 v[236:239], a[232:235], v[40:43], v[236:239]
    v_mfma_f32_16x16x32_bf16 v[236:239], a[244:247], v[44:47], v[236:239]
    v_mfma_f32_16x16x32_bf16 v[240:243], a[8:11], v[72:75], v[28:31]
    v_mfma_f32_16x16x32_bf16 v[240:243], a[20:23], v[76:79], v[240:243]
    v_mfma_f32_16x16x32_bf16 v[240:243], a[32:35], v[172:175], v[240:243]
    v_mfma_f32_16x16x32_bf16 v[240:243], a[116:119], v[176:179], v[240:243]
    v_mfma_f32_16x16x32_bf16 v[240:243], a[128:131], v[180:183], v[240:243]
    v_mfma_f32_16x16x32_bf16 v[240:243], a[140:143], v[32:35], v[240:243]
    v_mfma_f32_16x16x32_bf16 v[240:243], a[224:227], v[36:39], v[240:243]
    v_mfma_f32_16x16x32_bf16 v[240:243], a[236:239], v[40:43], v[240:243]
    v_mfma_f32_16x16x32_bf16 v[240:243], a[248:251], v[44:47], v[240:243]
    v_mfma_f32_16x16x32_bf16 v[244:247], a[72:75], v[176:179], v[244:247]
    v_mfma_f32_16x16x32_bf16 v[244:247], a[84:87], v[180:183], v[244:247]
    v_mfma_f32_16x16x32_bf16 v[244:247], a[96:99], v[32:35], v[244:247]
    v_mfma_f32_16x16x32_bf16 v[244:247], a[180:183], v[36:39], v[244:247]
    v_mfma_f32_16x16x32_bf16 v[244:247], a[192:195], v[40:43], v[244:247]
    v_mfma_f32_16x16x32_bf16 v[244:247], a[204:207], v[44:47], v[244:247]
    s_waitcnt lgkmcnt(0)
    v_mfma_f32_16x16x32_bf16 v[244:247], v[112:115], v[48:51], v[244:247]
    v_mfma_f32_16x16x32_bf16 v[244:247], v[124:127], v[52:55], v[244:247]
    v_mfma_f32_16x16x32_bf16 v[244:247], v[136:139], v[56:59], v[244:247]
    v_mfma_f32_16x16x32_bf16 v[248:251], a[76:79], v[176:179], v[248:251]
    v_mfma_f32_16x16x32_bf16 v[248:251], a[88:91], v[180:183], v[248:251]
    v_mfma_f32_16x16x32_bf16 v[248:251], a[100:103], v[32:35], v[248:251]
    v_mfma_f32_16x16x32_bf16 v[248:251], a[184:187], v[36:39], v[248:251]
    v_mfma_f32_16x16x32_bf16 v[248:251], a[196:199], v[40:43], v[248:251]
    v_mfma_f32_16x16x32_bf16 v[248:251], a[208:211], v[44:47], v[248:251]
    v_mfma_f32_16x16x32_bf16 v[248:251], v[116:119], v[48:51], v[248:251]
    v_mfma_f32_16x16x32_bf16 v[248:251], v[128:131], v[52:55], v[248:251]
    v_cvt_pk_bf16_f32 v244, v244, v245
    v_cvt_pk_bf16_f32 v245, v246, v247
    v_mfma_f32_16x16x32_bf16 v[248:251], v[140:143], v[56:59], v[248:251]
    ds_write_b32 v14, v244 offset:384
    v_mfma_f32_16x16x32_bf16 v[252:255], a[80:83], v[176:179], v[252:255]
    ds_write_b32 v14, v245 offset:388
    v_mfma_f32_16x16x32_bf16 v[252:255], a[92:95], v[180:183], v[252:255]
    v_mfma_f32_16x16x32_bf16 v[252:255], a[104:107], v[32:35], v[252:255]
    v_mfma_f32_16x16x32_bf16 v[252:255], a[188:191], v[36:39], v[252:255]
    v_mfma_f32_16x16x32_bf16 v[252:255], a[200:203], v[40:43], v[252:255]
    v_mfma_f32_16x16x32_bf16 v[252:255], a[212:215], v[44:47], v[252:255]
    v_mfma_f32_16x16x32_bf16 v[252:255], v[120:123], v[48:51], v[252:255]
    v_mfma_f32_16x16x32_bf16 v[252:255], v[132:135], v[52:55], v[252:255]
    v_cvt_pk_bf16_f32 v248, v248, v249
    v_cvt_pk_bf16_f32 v249, v250, v251
    v_mfma_f32_16x16x32_bf16 v[252:255], v[144:147], v[56:59], v[252:255]
    ds_write_b32 v15, v248 offset:384
    v_mfma_f32_16x16x32_bf16 v[208:211], a[36:39], v[176:179], v[208:211]
    ds_write_b32 v15, v249 offset:388
    v_mfma_f32_16x16x32_bf16 v[208:211], a[48:51], v[180:183], v[208:211]
    v_mfma_f32_16x16x32_bf16 v[208:211], a[60:63], v[32:35], v[208:211]
    v_mfma_f32_16x16x32_bf16 v[208:211], a[144:147], v[36:39], v[208:211]
    v_mfma_f32_16x16x32_bf16 v[208:211], a[156:159], v[40:43], v[208:211]
    v_mfma_f32_16x16x32_bf16 v[208:211], a[168:171], v[44:47], v[208:211]
    v_mfma_f32_16x16x32_bf16 v[208:211], a[252:255], v[48:51], v[208:211]
    v_mfma_f32_16x16x32_bf16 v[208:211], v[88:91], v[52:55], v[208:211]
    v_cvt_pk_bf16_f32 v252, v252, v253
    v_cvt_pk_bf16_f32 v253, v254, v255
    v_mfma_f32_16x16x32_bf16 v[208:211], v[100:103], v[56:59], v[208:211]
    ds_write_b32 v14, v252 offset:448
    v_mfma_f32_16x16x32_bf16 v[212:215], a[40:43], v[176:179], v[212:215]
    ds_write_b32 v14, v253 offset:452
    v_mfma_f32_16x16x32_bf16 v[212:215], a[52:55], v[180:183], v[212:215]
    v_mfma_f32_16x16x32_bf16 v[212:215], a[64:67], v[32:35], v[212:215]
    v_add_u32 v1, 0xffff6a00, v1
    v_add_u32 v2, 0xffff6a00, v2
    v_add_u32 v3, 0xffff6a00, v3
    v_mfma_f32_16x16x32_bf16 v[212:215], a[148:151], v[36:39], v[212:215]
    v_add_u32 v16, 0xffff6a00, v16
    v_add_u32 v17, 0xffff6a00, v17
    v_mfma_f32_16x16x32_bf16 v[212:215], a[160:163], v[40:43], v[212:215]
    v_mfma_f32_16x16x32_bf16 v[212:215], a[172:175], v[44:47], v[212:215]
    v_mfma_f32_16x16x32_bf16 v[212:215], v[80:83], v[48:51], v[212:215]
    v_mfma_f32_16x16x32_bf16 v[212:215], v[92:95], v[52:55], v[212:215]
    v_mfma_f32_16x16x32_bf16 v[212:215], v[104:107], v[56:59], v[212:215]
    v_mfma_f32_16x16x32_bf16 v[216:219], a[44:47], v[176:179], v[216:219]
    s_waitcnt vmcnt(10) lgkmcnt(0)
    v_mfma_f32_16x16x32_bf16 v[216:219], a[56:59], v[180:183], v[216:219]
    s_barrier
    v_mfma_f32_16x16x32_bf16 v[216:219], a[68:71], v[32:35], v[216:219]
    ds_read_b128 v[60:63], v1 offset:0
    v_mfma_f32_16x16x32_bf16 v[216:219], a[152:155], v[36:39], v[216:219]
    ds_read_b128 v[64:67], v1 offset:64
    v_mfma_f32_16x16x32_bf16 v[216:219], a[164:167], v[40:43], v[216:219]
    ds_read_b128 v[168:171], v1 offset:128
    v_mfma_f32_16x16x32_bf16 v[216:219], a[176:179], v[44:47], v[216:219]
    ds_read_b128 v[68:71], v2 offset:0
    v_mfma_f32_16x16x32_bf16 v[216:219], v[84:87], v[48:51], v[216:219]
    ds_read_b128 v[72:75], v2 offset:64
    v_mfma_f32_16x16x32_bf16 v[216:219], v[96:99], v[52:55], v[216:219]
    ds_read_b128 v[76:79], v2 offset:128
    v_mfma_f32_16x16x32_bf16 v[216:219], v[108:111], v[56:59], v[216:219]
    ds_read_b128 v[172:175], v3 offset:0
    v_mfma_f32_16x16x32_bf16 v[244:247], a[0:3], v[176:179], v[20:23]
    ds_read_b128 v[148:151], v9 offset:0
    v_mfma_f32_16x16x32_bf16 v[244:247], a[12:15], v[180:183], v[244:247]
    ds_read_b128 v[152:155], v10 offset:0
    v_mfma_f32_16x16x32_bf16 v[244:247], a[24:27], v[32:35], v[244:247]
    ds_read_b128 v[156:159], v11 offset:0
    v_mfma_f32_16x16x32_bf16 v[244:247], a[108:111], v[36:39], v[244:247]
    ds_read_b128 v[160:163], v12 offset:0
    v_mfma_f32_16x16x32_bf16 v[244:247], a[120:123], v[40:43], v[244:247]
    ds_read_b128 v[164:167], v13 offset:0
    v_mfma_f32_16x16x32_bf16 v[244:247], a[132:135], v[44:47], v[244:247]
    v_mfma_f32_16x16x32_bf16 v[244:247], a[216:219], v[48:51], v[244:247]
    v_mfma_f32_16x16x32_bf16 v[244:247], a[228:231], v[52:55], v[244:247]
    v_mfma_f32_16x16x32_bf16 v[244:247], a[240:243], v[56:59], v[244:247]
    v_mfma_f32_16x16x32_bf16 v[248:251], a[4:7], v[176:179], v[24:27]
    v_mfma_f32_16x16x32_bf16 v[248:251], a[16:19], v[180:183], v[248:251]
    s_add_u32 s43, s20, 147456
    v_mfma_f32_16x16x32_bf16 v[248:251], a[28:31], v[32:35], v[248:251]
    s_waitcnt lgkmcnt(4)
    buffer_store_dwordx4 v[148:151], v19, s[24:27], s43 offen offset:0 sc0 sc1
    v_mfma_f32_16x16x32_bf16 v[248:251], a[112:115], v[36:39], v[248:251]
    v_mfma_f32_16x16x32_bf16 v[248:251], a[124:127], v[40:43], v[248:251]
    v_mfma_f32_16x16x32_bf16 v[248:251], a[136:139], v[44:47], v[248:251]
    v_mfma_f32_16x16x32_bf16 v[248:251], a[220:223], v[48:51], v[248:251]
    v_mfma_f32_16x16x32_bf16 v[248:251], a[232:235], v[52:55], v[248:251]
    v_mfma_f32_16x16x32_bf16 v[248:251], a[244:247], v[56:59], v[248:251]
    v_mfma_f32_16x16x32_bf16 v[252:255], a[8:11], v[176:179], v[28:31]
    ds_read_b128 v[176:179], v3 offset:64
    v_mfma_f32_16x16x32_bf16 v[252:255], a[20:23], v[180:183], v[252:255]
    ds_read_b128 v[180:183], v3 offset:128
    v_mfma_f32_16x16x32_bf16 v[252:255], a[32:35], v[32:35], v[252:255]
    v_mfma_f32_16x16x32_bf16 v[252:255], a[116:119], v[36:39], v[252:255]
    v_mfma_f32_16x16x32_bf16 v[252:255], a[128:131], v[40:43], v[252:255]
    v_mfma_f32_16x16x32_bf16 v[252:255], a[140:143], v[44:47], v[252:255]
    v_mfma_f32_16x16x32_bf16 v[252:255], a[224:227], v[48:51], v[252:255]
    v_mfma_f32_16x16x32_bf16 v[252:255], a[236:239], v[52:55], v[252:255]
    s_waitcnt lgkmcnt(2)
    buffer_store_dwordx4 v[152:155], v19, s[24:27], s43 offen offset:1024 sc0 sc1
    v_mfma_f32_16x16x32_bf16 v[252:255], a[248:251], v[56:59], v[252:255]
    ds_read_b128 v[32:35], v16 offset:0
    v_mfma_f32_16x16x32_bf16 v[184:187], a[72:75], v[60:63], v[184:187]
    ds_read_b128 v[36:39], v16 offset:64
    v_mfma_f32_16x16x32_bf16 v[184:187], a[84:87], v[64:67], v[184:187]
    ds_read_b128 v[40:43], v16 offset:128
    v_mfma_f32_16x16x32_bf16 v[184:187], a[96:99], v[168:171], v[184:187]
    v_mfma_f32_16x16x32_bf16 v[184:187], a[180:183], v[68:71], v[184:187]
    v_mfma_f32_16x16x32_bf16 v[184:187], a[192:195], v[72:75], v[184:187]
    v_mfma_f32_16x16x32_bf16 v[184:187], a[204:207], v[76:79], v[184:187]
    v_mfma_f32_16x16x32_bf16 v[184:187], v[112:115], v[172:175], v[184:187]
    s_waitcnt lgkmcnt(3)
    v_mfma_f32_16x16x32_bf16 v[184:187], v[124:127], v[176:179], v[184:187]
    v_mfma_f32_16x16x32_bf16 v[184:187], v[136:139], v[180:183], v[184:187]
    v_mfma_f32_16x16x32_bf16 v[188:191], a[76:79], v[60:63], v[188:191]
    v_mfma_f32_16x16x32_bf16 v[188:191], a[88:91], v[64:67], v[188:191]
    v_mfma_f32_16x16x32_bf16 v[188:191], a[100:103], v[168:171], v[188:191]
    v_mfma_f32_16x16x32_bf16 v[188:191], a[184:187], v[68:71], v[188:191]
    buffer_store_dwordx4 v[156:159], v19, s[24:27], s43 offen offset:2048 sc0 sc1
    v_mfma_f32_16x16x32_bf16 v[188:191], a[196:199], v[72:75], v[188:191]
    v_mfma_f32_16x16x32_bf16 v[188:191], a[208:211], v[76:79], v[188:191]
    v_mfma_f32_16x16x32_bf16 v[188:191], v[116:119], v[172:175], v[188:191]
    v_mfma_f32_16x16x32_bf16 v[188:191], v[128:131], v[176:179], v[188:191]
    v_cvt_pk_bf16_f32 v184, v184, v185
    v_cvt_pk_bf16_f32 v185, v186, v187
    v_mfma_f32_16x16x32_bf16 v[188:191], v[140:143], v[180:183], v[188:191]
    ds_write_b32 v14, v184 offset:19200
    v_mfma_f32_16x16x32_bf16 v[192:195], a[80:83], v[60:63], v[192:195]
    ds_write_b32 v14, v185 offset:19204
    v_mfma_f32_16x16x32_bf16 v[192:195], a[92:95], v[64:67], v[192:195]
    v_mfma_f32_16x16x32_bf16 v[192:195], a[104:107], v[168:171], v[192:195]
    v_mfma_f32_16x16x32_bf16 v[192:195], a[188:191], v[68:71], v[192:195]
    v_mfma_f32_16x16x32_bf16 v[192:195], a[200:203], v[72:75], v[192:195]
    v_mfma_f32_16x16x32_bf16 v[192:195], a[212:215], v[76:79], v[192:195]
    v_mfma_f32_16x16x32_bf16 v[192:195], v[120:123], v[172:175], v[192:195]
    v_mfma_f32_16x16x32_bf16 v[192:195], v[132:135], v[176:179], v[192:195]
    v_cvt_pk_bf16_f32 v188, v188, v189
    v_cvt_pk_bf16_f32 v189, v190, v191
    v_mfma_f32_16x16x32_bf16 v[192:195], v[144:147], v[180:183], v[192:195]
    ds_write_b32 v15, v188 offset:19200
    v_mfma_f32_16x16x32_bf16 v[220:223], a[36:39], v[60:63], v[220:223]
    ds_write_b32 v15, v189 offset:19204
    v_mfma_f32_16x16x32_bf16 v[220:223], a[48:51], v[64:67], v[220:223]
    v_mfma_f32_16x16x32_bf16 v[220:223], a[60:63], v[168:171], v[220:223]
    buffer_store_dwordx4 v[160:163], v19, s[24:27], s43 offen offset:3072 sc0 sc1
    v_mfma_f32_16x16x32_bf16 v[220:223], a[144:147], v[68:71], v[220:223]
    v_mfma_f32_16x16x32_bf16 v[220:223], a[156:159], v[72:75], v[220:223]
    v_mfma_f32_16x16x32_bf16 v[220:223], a[168:171], v[76:79], v[220:223]
    v_mfma_f32_16x16x32_bf16 v[220:223], a[252:255], v[172:175], v[220:223]
    v_mfma_f32_16x16x32_bf16 v[220:223], v[88:91], v[176:179], v[220:223]
    v_cvt_pk_bf16_f32 v192, v192, v193
    v_cvt_pk_bf16_f32 v193, v194, v195
    v_mfma_f32_16x16x32_bf16 v[220:223], v[100:103], v[180:183], v[220:223]
    ds_write_b32 v14, v192 offset:19264
    v_mfma_f32_16x16x32_bf16 v[224:227], a[40:43], v[60:63], v[224:227]
    ds_write_b32 v14, v193 offset:19268
    v_mfma_f32_16x16x32_bf16 v[224:227], a[52:55], v[64:67], v[224:227]
    v_mfma_f32_16x16x32_bf16 v[224:227], a[64:67], v[168:171], v[224:227]
    v_mfma_f32_16x16x32_bf16 v[224:227], a[148:151], v[68:71], v[224:227]
    v_mfma_f32_16x16x32_bf16 v[224:227], a[160:163], v[72:75], v[224:227]
    v_mfma_f32_16x16x32_bf16 v[224:227], a[172:175], v[76:79], v[224:227]
    v_mfma_f32_16x16x32_bf16 v[224:227], v[80:83], v[172:175], v[224:227]
    v_mfma_f32_16x16x32_bf16 v[224:227], v[92:95], v[176:179], v[224:227]
    s_mov_b32 exec_lo, 0
    buffer_store_dwordx4 v[164:167], v19, s[24:27], s43 offen offset:3584 sc0 sc1
    s_mov_b32 exec_lo, -1
    v_mfma_f32_16x16x32_bf16 v[224:227], v[104:107], v[180:183], v[224:227]
    v_mfma_f32_16x16x32_bf16 v[228:231], a[44:47], v[60:63], v[228:231]
    v_mfma_f32_16x16x32_bf16 v[228:231], a[56:59], v[64:67], v[228:231]
    v_mfma_f32_16x16x32_bf16 v[228:231], a[68:71], v[168:171], v[228:231]
    v_mfma_f32_16x16x32_bf16 v[228:231], a[152:155], v[68:71], v[228:231]
    v_mfma_f32_16x16x32_bf16 v[228:231], a[164:167], v[72:75], v[228:231]
    v_mfma_f32_16x16x32_bf16 v[228:231], a[176:179], v[76:79], v[228:231]
    v_mfma_f32_16x16x32_bf16 v[228:231], v[84:87], v[172:175], v[228:231]
    v_mfma_f32_16x16x32_bf16 v[228:231], v[96:99], v[176:179], v[228:231]
    v_mfma_f32_16x16x32_bf16 v[228:231], v[108:111], v[180:183], v[228:231]
    ds_read_b128 v[44:47], v17 offset:0
    v_mfma_f32_16x16x32_bf16 v[196:199], a[72:75], v[68:71], v[196:199]
    ds_read_b128 v[48:51], v17 offset:64
    v_mfma_f32_16x16x32_bf16 v[196:199], a[84:87], v[72:75], v[196:199]
    ds_read_b128 v[52:55], v17 offset:128
    v_mfma_f32_16x16x32_bf16 v[196:199], a[96:99], v[76:79], v[196:199]
    v_mfma_f32_16x16x32_bf16 v[196:199], a[180:183], v[172:175], v[196:199]
    v_mfma_f32_16x16x32_bf16 v[196:199], a[192:195], v[176:179], v[196:199]
    v_mfma_f32_16x16x32_bf16 v[196:199], a[204:207], v[180:183], v[196:199]
    s_waitcnt lgkmcnt(3)
    v_mfma_f32_16x16x32_bf16 v[196:199], v[112:115], v[32:35], v[196:199]
    v_mfma_f32_16x16x32_bf16 v[196:199], v[124:127], v[36:39], v[196:199]
    v_mfma_f32_16x16x32_bf16 v[196:199], v[136:139], v[40:43], v[196:199]
    v_mfma_f32_16x16x32_bf16 v[200:203], a[76:79], v[68:71], v[200:203]
    v_mfma_f32_16x16x32_bf16 v[200:203], a[88:91], v[72:75], v[200:203]
    v_mfma_f32_16x16x32_bf16 v[200:203], a[100:103], v[76:79], v[200:203]
    v_mfma_f32_16x16x32_bf16 v[200:203], a[184:187], v[172:175], v[200:203]
    v_mfma_f32_16x16x32_bf16 v[200:203], a[196:199], v[176:179], v[200:203]
    v_mfma_f32_16x16x32_bf16 v[200:203], a[208:211], v[180:183], v[200:203]
    v_mfma_f32_16x16x32_bf16 v[200:203], v[116:119], v[32:35], v[200:203]
    v_mfma_f32_16x16x32_bf16 v[200:203], v[128:131], v[36:39], v[200:203]
    v_cvt_pk_bf16_f32 v196, v196, v197
    v_cvt_pk_bf16_f32 v197, v198, v199
    v_mfma_f32_16x16x32_bf16 v[200:203], v[140:143], v[40:43], v[200:203]
    ds_write_b32 v14, v196 offset:19392
    v_mfma_f32_16x16x32_bf16 v[204:207], a[80:83], v[68:71], v[204:207]
    ds_write_b32 v14, v197 offset:19396
    v_mfma_f32_16x16x32_bf16 v[204:207], a[92:95], v[72:75], v[204:207]
    v_mfma_f32_16x16x32_bf16 v[204:207], a[104:107], v[76:79], v[204:207]
    v_mfma_f32_16x16x32_bf16 v[204:207], a[188:191], v[172:175], v[204:207]
    v_mfma_f32_16x16x32_bf16 v[204:207], a[200:203], v[176:179], v[204:207]
    v_mfma_f32_16x16x32_bf16 v[204:207], a[212:215], v[180:183], v[204:207]
    v_mfma_f32_16x16x32_bf16 v[204:207], v[120:123], v[32:35], v[204:207]
    v_mfma_f32_16x16x32_bf16 v[204:207], v[132:135], v[36:39], v[204:207]
    v_cvt_pk_bf16_f32 v200, v200, v201
    v_cvt_pk_bf16_f32 v201, v202, v203
    v_mfma_f32_16x16x32_bf16 v[204:207], v[144:147], v[40:43], v[204:207]
    ds_write_b32 v15, v200 offset:19392
    v_mfma_f32_16x16x32_bf16 v[232:235], a[36:39], v[68:71], v[232:235]
    ds_write_b32 v15, v201 offset:19396
    v_mfma_f32_16x16x32_bf16 v[232:235], a[48:51], v[72:75], v[232:235]
    v_mfma_f32_16x16x32_bf16 v[232:235], a[60:63], v[76:79], v[232:235]
    v_mfma_f32_16x16x32_bf16 v[232:235], a[144:147], v[172:175], v[232:235]
    v_mfma_f32_16x16x32_bf16 v[232:235], a[156:159], v[176:179], v[232:235]
    v_mfma_f32_16x16x32_bf16 v[232:235], a[168:171], v[180:183], v[232:235]
    v_mfma_f32_16x16x32_bf16 v[232:235], a[252:255], v[32:35], v[232:235]
    v_mfma_f32_16x16x32_bf16 v[232:235], v[88:91], v[36:39], v[232:235]
    v_cvt_pk_bf16_f32 v204, v204, v205
    v_cvt_pk_bf16_f32 v205, v206, v207
    v_mfma_f32_16x16x32_bf16 v[232:235], v[100:103], v[40:43], v[232:235]
    ds_write_b32 v14, v204 offset:19456
    v_mfma_f32_16x16x32_bf16 v[236:239], a[40:43], v[68:71], v[236:239]
    ds_write_b32 v14, v205 offset:19460
    v_mfma_f32_16x16x32_bf16 v[236:239], a[52:55], v[72:75], v[236:239]
    v_mfma_f32_16x16x32_bf16 v[236:239], a[64:67], v[76:79], v[236:239]
    v_mfma_f32_16x16x32_bf16 v[236:239], a[148:151], v[172:175], v[236:239]
    v_mfma_f32_16x16x32_bf16 v[236:239], a[160:163], v[176:179], v[236:239]
    v_mfma_f32_16x16x32_bf16 v[236:239], a[172:175], v[180:183], v[236:239]
    v_mfma_f32_16x16x32_bf16 v[236:239], v[80:83], v[32:35], v[236:239]
    v_mfma_f32_16x16x32_bf16 v[236:239], v[92:95], v[36:39], v[236:239]
    v_mfma_f32_16x16x32_bf16 v[236:239], v[104:107], v[40:43], v[236:239]
    v_mfma_f32_16x16x32_bf16 v[240:243], a[44:47], v[68:71], v[240:243]
    v_mfma_f32_16x16x32_bf16 v[240:243], a[56:59], v[72:75], v[240:243]
    v_mfma_f32_16x16x32_bf16 v[240:243], a[68:71], v[76:79], v[240:243]
    v_mfma_f32_16x16x32_bf16 v[240:243], a[152:155], v[172:175], v[240:243]
    v_mfma_f32_16x16x32_bf16 v[240:243], a[164:167], v[176:179], v[240:243]
    v_mfma_f32_16x16x32_bf16 v[240:243], a[176:179], v[180:183], v[240:243]
    v_mfma_f32_16x16x32_bf16 v[240:243], v[84:87], v[32:35], v[240:243]
    v_mfma_f32_16x16x32_bf16 v[240:243], v[96:99], v[36:39], v[240:243]
    v_mfma_f32_16x16x32_bf16 v[240:243], v[108:111], v[40:43], v[240:243]
    v_mfma_f32_16x16x32_bf16 v[208:211], a[72:75], v[172:175], v[208:211]
    v_mfma_f32_16x16x32_bf16 v[208:211], a[84:87], v[176:179], v[208:211]
    v_mfma_f32_16x16x32_bf16 v[208:211], a[96:99], v[180:183], v[208:211]
    v_mfma_f32_16x16x32_bf16 v[208:211], a[180:183], v[32:35], v[208:211]
    v_mfma_f32_16x16x32_bf16 v[208:211], a[192:195], v[36:39], v[208:211]
    v_mfma_f32_16x16x32_bf16 v[208:211], a[204:207], v[40:43], v[208:211]
    v_add_u32 v1, 0xffff4480, v1
    v_add_u32 v2, 0xffff4480, v2
    v_add_u32 v3, 0xffff4480, v3
    s_waitcnt lgkmcnt(0)
    v_mfma_f32_16x16x32_bf16 v[208:211], v[112:115], v[44:47], v[208:211]
    v_add_u32 v16, 0xffff4480, v16
    v_add_u32 v17, 0xffff4480, v17
    v_mfma_f32_16x16x32_bf16 v[208:211], v[124:127], v[48:51], v[208:211]
    v_mfma_f32_16x16x32_bf16 v[208:211], v[136:139], v[52:55], v[208:211]
    v_mfma_f32_16x16x32_bf16 v[212:215], a[76:79], v[172:175], v[212:215]
    v_mfma_f32_16x16x32_bf16 v[212:215], a[88:91], v[176:179], v[212:215]
    v_mfma_f32_16x16x32_bf16 v[212:215], a[100:103], v[180:183], v[212:215]
    v_mfma_f32_16x16x32_bf16 v[212:215], a[184:187], v[32:35], v[212:215]
    s_waitcnt vmcnt(5)
    v_mfma_f32_16x16x32_bf16 v[212:215], a[196:199], v[36:39], v[212:215]
    s_barrier
    v_mfma_f32_16x16x32_bf16 v[212:215], a[208:211], v[40:43], v[212:215]
    ds_read_b128 v[56:59], v1 offset:0
    v_mfma_f32_16x16x32_bf16 v[212:215], v[116:119], v[44:47], v[212:215]
    ds_read_b128 v[60:63], v1 offset:64
    v_mfma_f32_16x16x32_bf16 v[212:215], v[128:131], v[48:51], v[212:215]
    v_cvt_pk_bf16_f32 v208, v208, v209
    v_cvt_pk_bf16_f32 v209, v210, v211
    v_mfma_f32_16x16x32_bf16 v[212:215], v[140:143], v[52:55], v[212:215]
    ds_write_b32 v14, v208 offset:19584
    v_mfma_f32_16x16x32_bf16 v[216:219], a[80:83], v[172:175], v[216:219]
    ds_write_b32 v14, v209 offset:19588
    v_mfma_f32_16x16x32_bf16 v[216:219], a[92:95], v[176:179], v[216:219]
    ds_read_b128 v[64:67], v1 offset:128
    v_mfma_f32_16x16x32_bf16 v[216:219], a[104:107], v[180:183], v[216:219]
    ds_read_b128 v[168:171], v2 offset:0
    v_mfma_f32_16x16x32_bf16 v[216:219], a[188:191], v[32:35], v[216:219]
    ds_read_b128 v[68:71], v2 offset:64
    v_mfma_f32_16x16x32_bf16 v[216:219], a[200:203], v[36:39], v[216:219]
    ds_read_b128 v[72:75], v2 offset:128
    v_mfma_f32_16x16x32_bf16 v[216:219], a[212:215], v[40:43], v[216:219]
    ds_read_b128 v[76:79], v3 offset:0
    v_mfma_f32_16x16x32_bf16 v[216:219], v[120:123], v[44:47], v[216:219]
    v_mfma_f32_16x16x32_bf16 v[216:219], v[132:135], v[48:51], v[216:219]
    v_cvt_pk_bf16_f32 v212, v212, v213
    v_cvt_pk_bf16_f32 v213, v214, v215
    v_mfma_f32_16x16x32_bf16 v[216:219], v[144:147], v[52:55], v[216:219]
    ds_write_b32 v15, v212 offset:19584
    v_mfma_f32_16x16x32_bf16 v[244:247], a[36:39], v[172:175], v[244:247]
    ds_write_b32 v15, v213 offset:19588
    v_mfma_f32_16x16x32_bf16 v[244:247], a[48:51], v[176:179], v[244:247]
    v_mfma_f32_16x16x32_bf16 v[244:247], a[60:63], v[180:183], v[244:247]
    v_mfma_f32_16x16x32_bf16 v[244:247], a[144:147], v[32:35], v[244:247]
    v_mfma_f32_16x16x32_bf16 v[244:247], a[156:159], v[36:39], v[244:247]
    v_mfma_f32_16x16x32_bf16 v[244:247], a[168:171], v[40:43], v[244:247]
    v_mfma_f32_16x16x32_bf16 v[244:247], a[252:255], v[44:47], v[244:247]
    v_mfma_f32_16x16x32_bf16 v[244:247], v[88:91], v[48:51], v[244:247]
    v_cvt_pk_bf16_f32 v216, v216, v217
    v_cvt_pk_bf16_f32 v217, v218, v219
    v_mfma_f32_16x16x32_bf16 v[244:247], v[100:103], v[52:55], v[244:247]
    ds_write_b32 v14, v216 offset:19648
    v_mfma_f32_16x16x32_bf16 v[248:251], a[40:43], v[172:175], v[248:251]
    ds_write_b32 v14, v217 offset:19652
    v_mfma_f32_16x16x32_bf16 v[248:251], a[52:55], v[176:179], v[248:251]
    v_mfma_f32_16x16x32_bf16 v[248:251], a[64:67], v[180:183], v[248:251]
    v_mfma_f32_16x16x32_bf16 v[248:251], a[148:151], v[32:35], v[248:251]
    v_mfma_f32_16x16x32_bf16 v[248:251], a[160:163], v[36:39], v[248:251]
    v_mfma_f32_16x16x32_bf16 v[248:251], a[172:175], v[40:43], v[248:251]
    v_mfma_f32_16x16x32_bf16 v[248:251], v[80:83], v[44:47], v[248:251]
    v_mfma_f32_16x16x32_bf16 v[248:251], v[92:95], v[48:51], v[248:251]
    v_mfma_f32_16x16x32_bf16 v[248:251], v[104:107], v[52:55], v[248:251]
    v_mfma_f32_16x16x32_bf16 v[252:255], a[44:47], v[172:175], v[252:255]
    ds_read_b128 v[172:175], v3 offset:64
    s_waitcnt lgkmcnt(1)
    v_mfma_f32_16x16x32_bf16 v[252:255], a[56:59], v[176:179], v[252:255]
    s_barrier
    v_mfma_f32_16x16x32_bf16 v[252:255], a[68:71], v[180:183], v[252:255]
    ds_read_b128 v[176:179], v3 offset:128
    v_mfma_f32_16x16x32_bf16 v[252:255], a[152:155], v[32:35], v[252:255]
    ds_read_b128 v[180:183], v16 offset:0
    v_mfma_f32_16x16x32_bf16 v[252:255], a[164:167], v[36:39], v[252:255]
    ds_read_b128 v[32:35], v16 offset:64
    v_mfma_f32_16x16x32_bf16 v[252:255], a[176:179], v[40:43], v[252:255]
    ds_read_b128 v[36:39], v16 offset:128
    v_mfma_f32_16x16x32_bf16 v[252:255], v[84:87], v[44:47], v[252:255]
    ds_read_b128 v[148:151], v9 offset:19200
    v_mfma_f32_16x16x32_bf16 v[252:255], v[96:99], v[48:51], v[252:255]
    ds_read_b128 v[152:155], v10 offset:19200
    v_mfma_f32_16x16x32_bf16 v[252:255], v[108:111], v[52:55], v[252:255]
    ds_read_b128 v[40:43], v17 offset:0
    v_mfma_f32_16x16x32_bf16 v[220:223], a[72:75], v[56:59], v[220:223]
    ds_read_b128 v[44:47], v17 offset:64
    v_mfma_f32_16x16x32_bf16 v[220:223], a[84:87], v[60:63], v[220:223]
    ds_read_b128 v[48:51], v17 offset:128
    v_mfma_f32_16x16x32_bf16 v[220:223], a[96:99], v[64:67], v[220:223]
    ds_read_b128 v[156:159], v11 offset:19200
    v_mfma_f32_16x16x32_bf16 v[220:223], a[180:183], v[168:171], v[220:223]
    ds_read_b128 v[160:163], v12 offset:19200
    v_mfma_f32_16x16x32_bf16 v[220:223], a[192:195], v[68:71], v[220:223]
    ds_read_b128 v[164:167], v13 offset:19200
    v_mfma_f32_16x16x32_bf16 v[220:223], a[204:207], v[72:75], v[220:223]
    v_mfma_f32_16x16x32_bf16 v[220:223], v[112:115], v[76:79], v[220:223]
    s_waitcnt lgkmcnt(10)
    v_mfma_f32_16x16x32_bf16 v[220:223], v[124:127], v[172:175], v[220:223]
    v_mfma_f32_16x16x32_bf16 v[220:223], v[136:139], v[176:179], v[220:223]
    v_mfma_f32_16x16x32_bf16 v[224:227], a[76:79], v[56:59], v[224:227]
    v_mfma_f32_16x16x32_bf16 v[224:227], a[88:91], v[60:63], v[224:227]
    s_add_u32 s43, s20, 221184
    v_mfma_f32_16x16x32_bf16 v[224:227], a[100:103], v[64:67], v[224:227]
    s_waitcnt lgkmcnt(5)
    buffer_store_dwordx4 v[148:151], v19, s[24:27], s43 offen offset:0 sc0 sc1
    v_mfma_f32_16x16x32_bf16 v[224:227], a[184:187], v[168:171], v[224:227]
    v_mfma_f32_16x16x32_bf16 v[224:227], a[196:199], v[68:71], v[224:227]
    v_mfma_f32_16x16x32_bf16 v[224:227], a[208:211], v[72:75], v[224:227]
    v_mfma_f32_16x16x32_bf16 v[224:227], v[116:119], v[76:79], v[224:227]
    v_mfma_f32_16x16x32_bf16 v[224:227], v[128:131], v[172:175], v[224:227]
    v_cvt_pk_bf16_f32 v220, v220, v221
    v_cvt_pk_bf16_f32 v221, v222, v223
    v_mfma_f32_16x16x32_bf16 v[224:227], v[140:143], v[176:179], v[224:227]
    ds_write_b32 v14, v220 offset:0
    v_mfma_f32_16x16x32_bf16 v[228:231], a[80:83], v[56:59], v[228:231]
    ds_write_b32 v14, v221 offset:4
    v_mfma_f32_16x16x32_bf16 v[228:231], a[92:95], v[60:63], v[228:231]
    v_mfma_f32_16x16x32_bf16 v[228:231], a[104:107], v[64:67], v[228:231]
    buffer_store_dwordx4 v[152:155], v19, s[24:27], s43 offen offset:1024 sc0 sc1
    v_mfma_f32_16x16x32_bf16 v[228:231], a[188:191], v[168:171], v[228:231]
    v_mfma_f32_16x16x32_bf16 v[228:231], a[200:203], v[68:71], v[228:231]
    v_mfma_f32_16x16x32_bf16 v[228:231], a[212:215], v[72:75], v[228:231]
    v_mfma_f32_16x16x32_bf16 v[228:231], v[120:123], v[76:79], v[228:231]
    v_mfma_f32_16x16x32_bf16 v[228:231], v[132:135], v[172:175], v[228:231]
    v_cvt_pk_bf16_f32 v224, v224, v225
    v_cvt_pk_bf16_f32 v225, v226, v227
    v_mfma_f32_16x16x32_bf16 v[228:231], v[144:147], v[176:179], v[228:231]
    ds_write_b32 v15, v224 offset:0
    v_mfma_f32_16x16x32_bf16 v[232:235], a[72:75], v[168:171], v[232:235]
    ds_write_b32 v15, v225 offset:4
    v_mfma_f32_16x16x32_bf16 v[232:235], a[84:87], v[68:71], v[232:235]
    v_mfma_f32_16x16x32_bf16 v[232:235], a[96:99], v[72:75], v[232:235]
    s_waitcnt lgkmcnt(3)
    buffer_store_dwordx4 v[156:159], v19, s[24:27], s43 offen offset:2048 sc0 sc1
    v_mfma_f32_16x16x32_bf16 v[232:235], a[180:183], v[76:79], v[232:235]
    v_mfma_f32_16x16x32_bf16 v[232:235], a[192:195], v[172:175], v[232:235]
    v_mfma_f32_16x16x32_bf16 v[232:235], a[204:207], v[176:179], v[232:235]
    v_mfma_f32_16x16x32_bf16 v[232:235], v[112:115], v[180:183], v[232:235]
    v_mfma_f32_16x16x32_bf16 v[232:235], v[124:127], v[32:35], v[232:235]
    v_cvt_pk_bf16_f32 v228, v228, v229
    v_cvt_pk_bf16_f32 v229, v230, v231
    v_mfma_f32_16x16x32_bf16 v[232:235], v[136:139], v[36:39], v[232:235]
    ds_write_b32 v14, v228 offset:64
    v_mfma_f32_16x16x32_bf16 v[236:239], a[76:79], v[168:171], v[236:239]
    ds_write_b32 v14, v229 offset:68
    v_mfma_f32_16x16x32_bf16 v[236:239], a[88:91], v[68:71], v[236:239]
    v_mfma_f32_16x16x32_bf16 v[236:239], a[100:103], v[72:75], v[236:239]
    buffer_store_dwordx4 v[160:163], v19, s[24:27], s43 offen offset:3072 sc0 sc1
    v_mfma_f32_16x16x32_bf16 v[236:239], a[184:187], v[76:79], v[236:239]
    v_mfma_f32_16x16x32_bf16 v[236:239], a[196:199], v[172:175], v[236:239]
    ds_read_b128 v[52:55], v4 offset:48000
    v_mfma_f32_16x16x32_bf16 v[236:239], a[208:211], v[176:179], v[236:239]
    ds_read_b128 v[56:59], v4 offset:48064
    v_mfma_f32_16x16x32_bf16 v[236:239], v[116:119], v[180:183], v[236:239]
    ds_read_b128 v[60:63], v4 offset:48128
    v_mfma_f32_16x16x32_bf16 v[236:239], v[128:131], v[32:35], v[236:239]
    v_cvt_pk_bf16_f32 v232, v232, v233
    v_cvt_pk_bf16_f32 v233, v234, v235
    v_mfma_f32_16x16x32_bf16 v[236:239], v[140:143], v[36:39], v[236:239]
    ds_write_b32 v14, v232 offset:192
    v_mfma_f32_16x16x32_bf16 v[240:243], a[80:83], v[168:171], v[240:243]
    ds_write_b32 v14, v233 offset:196
    v_mfma_f32_16x16x32_bf16 v[240:243], a[92:95], v[68:71], v[240:243]
    ds_read_b128 v[64:67], v5 offset:48000
    v_mfma_f32_16x16x32_bf16 v[240:243], a[104:107], v[72:75], v[240:243]
    ds_read_b128 v[168:171], v5 offset:48064
    v_mfma_f32_16x16x32_bf16 v[240:243], a[188:191], v[76:79], v[240:243]
L_pad3:
    s_cbranch_vccnz L_padret
    ds_read_b128 v[68:71], v5 offset:48128
    v_mfma_f32_16x16x32_bf16 v[240:243], a[200:203], v[172:175], v[240:243]
    ds_read_b128 v[72:75], v6 offset:48000
    v_mfma_f32_16x16x32_bf16 v[240:243], a[212:215], v[176:179], v[240:243]
    s_mov_b32 exec_lo, 0
    buffer_store_dwordx4 v[164:167], v19, s[24:27], s43 offen offset:3584 sc0 sc1
    s_mov_b32 exec_lo, -1
    v_mfma_f32_16x16x32_bf16 v[240:243], v[120:123], v[180:183], v[240:243]
    v_mfma_f32_16x16x32_bf16 v[240:243], v[132:135], v[32:35], v[240:243]
    v_cvt_pk_bf16_f32 v236, v236, v237
    v_cvt_pk_bf16_f32 v237, v238, v239
    v_mfma_f32_16x16x32_bf16 v[240:243], v[144:147], v[36:39], v[240:243]
    ds_write_b32 v15, v236 offset:192
    v_mfma_f32_16x16x32_bf16 v[244:247], a[72:75], v[76:79], v[244:247]
    ds_write_b32 v15, v237 offset:196
    v_mfma_f32_16x16x32_bf16 v[244:247], a[84:87], v[172:175], v[244:247]
    v_mfma_f32_16x16x32_bf16 v[244:247], a[96:99], v[176:179], v[244:247]
    v_mfma_f32_16x16x32_bf16 v[244:247], a[180:183], v[180:183], v[244:247]
    v_mfma_f32_16x16x32_bf16 v[244:247], a[192:195], v[32:35], v[244:247]
    v_mfma_f32_16x16x32_bf16 v[244:247], a[204:207], v[36:39], v[244:247]
    v_mfma_f32_16x16x32_bf16 v[244:247], v[112:115], v[40:43], v[244:247]
    v_mfma_f32_16x16x32_bf16 v[244:247], v[124:127], v[44:47], v[244:247]
    v_cvt_pk_bf16_f32 v240, v240, v241
    v_cvt_pk_bf16_f32 v241, v242, v243
    v_mfma_f32_16x16x32_bf16 v[244:247], v[136:139], v[48:51], v[244:247]
    ds_write_b32 v14, v240 offset:256
    v_mfma_f32_16x16x32_bf16 v[248:251], a[76:79], v[76:79], v[248:251]
    ds_write_b32 v14, v241 offset:260
    v_mfma_f32_16x16x32_bf16 v[248:251], a[88:91], v[172:175], v[248:251]
    v_mfma_f32_16x16x32_bf16 v[248:251], a[100:103], v[176:179], v[248:251]
    v_mfma_f32_16x16x32_bf16 v[248:251], a[184:187], v[180:183], v[248:251]
    v_mfma_f32_16x16x32_bf16 v[248:251], a[196:199], v[32:35], v[248:251]
    v_mfma_f32_16x16x32_bf16 v[248:251], a[208:211], v[36:39], v[248:251]
    v_mfma_f32_16x16x32_bf16 v[248:251], v[116:119], v[40:43], v[248:251]
    v_mfma_f32_16x16x32_bf16 v[248:251], v[128:131], v[44:47], v[248:251]
    v_cvt_pk_bf16_f32 v244, v244, v245
    v_cvt_pk_bf16_f32 v245, v246, v247
    v_mfma_f32_16x16x32_bf16 v[248:251], v[140:143], v[48:51], v[248:251]
    ds_write_b32 v14, v244 offset:384
    v_mfma_f32_16x16x32_bf16 v[252:255], a[80:83], v[76:79], v[252:255]
    ds_write_b32 v14, v245 offset:388
    v_mfma_f32_16x16x32_bf16 v[252:255], a[92:95], v[172:175], v[252:255]
    ds_read_b128 v[76:79], v6 offset:48064
    v_mfma_f32_16x16x32_bf16 v[252:255], a[104:107], v[176:179], v[252:255]
    ds_read_b128 v[172:175], v6 offset:48128
    v_mfma_f32_16x16x32_bf16 v[252:255], a[188:191], v[180:183], v[252:255]
    ds_read_b128 v[176:179], v4 offset:0
    v_mfma_f32_16x16x32_bf16 v[252:255], a[200:203], v[32:35], v[252:255]
    ds_read_b128 v[180:183], v4 offset:64
    v_mfma_f32_16x16x32_bf16 v[252:255], a[212:215], v[36:39], v[252:255]
    ds_read_b128 v[32:35], v4 offset:128
    v_mfma_f32_16x16x32_bf16 v[252:255], v[120:123], v[40:43], v[252:255]
    ds_read_b128 v[36:39], v5 offset:0
    v_mfma_f32_16x16x32_bf16 v[252:255], v[132:135], v[44:47], v[252:255]
    v_cvt_pk_bf16_f32 v248, v248, v249
    v_cvt_pk_bf16_f32 v249, v250, v251
    v_mfma_f32_16x16x32_bf16 v[252:255], v[144:147], v[48:51], v[252:255]
    ds_write_b32 v15, v248 offset:384
    s_waitcnt lgkmcnt(9)
    v_mfma_f32_16x16x32_bf16 v[184:187], a[0:3], v[52:55], v[20:23]
    ds_write_b32 v15, v249 offset:388
    v_mfma_f32_16x16x32_bf16 v[184:187], a[12:15], v[56:59], v[184:187]
    ds_read_b128 v[40:43], v5 offset:64
    v_mfma_f32_16x16x32_bf16 v[184:187], a[24:27], v[60:63], v[184:187]
    ds_read_b128 v[44:47], v5 offset:128
    v_mfma_f32_16x16x32_bf16 v[184:187], a[108:111], v[64:67], v[184:187]
    ds_read_b128 v[48:51], v6 offset:0
    v_mfma_f32_16x16x32_bf16 v[184:187], a[120:123], v[168:171], v[184:187]
    v_mfma_f32_16x16x32_bf16 v[184:187], a[132:135], v[68:71], v[184:187]
    v_mfma_f32_16x16x32_bf16 v[184:187], a[216:219], v[72:75], v[184:187]
    s_waitcnt lgkmcnt(8)
    v_mfma_f32_16x16x32_bf16 v[184:187], a[228:231], v[76:79], v[184:187]
    v_cvt_pk_bf16_f32 v252, v252, v253
    v_cvt_pk_bf16_f32 v253, v254, v255
    v_mfma_f32_16x16x32_bf16 v[184:187], a[240:243], v[172:175], v[184:187]
    ds_write_b32 v14, v252 offset:448
    v_mfma_f32_16x16x32_bf16 v[188:191], a[4:7], v[52:55], v[24:27]
    ds_write_b32 v14, v253 offset:452
    v_mfma_f32_16x16x32_bf16 v[188:191], a[16:19], v[56:59], v[188:191]
    v_mfma_f32_16x16x32_bf16 v[188:191], a[28:31], v[60:63], v[188:191]
    s_movk_i32 s37, 384
    v_mfma_f32_16x16x32_bf16 v[188:191], a[112:115], v[64:67], v[188:191]
    v_and_b32 v18, 15, v0
    v_mfma_f32_16x16x32_bf16 v[188:191], a[124:127], v[168:171], v[188:191]
    v_mul_u32_u24 v18, s37, v18
    v_mfma_f32_16x16x32_bf16 v[188:191], a[136:139], v[68:71], v[188:191]
    v_sub_u32 v14, v14, v18
    v_mfma_f32_16x16x32_bf16 v[188:191], a[220:223], v[72:75], v[188:191]
    v_sub_u32 v15, v15, v18
    v_mfma_f32_16x16x32_bf16 v[188:191], a[232:235], v[76:79], v[188:191]
    v_mfma_f32_16x16x32_bf16 v[188:191], a[244:247], v[172:175], v[188:191]
    v_mfma_f32_16x16x32_bf16 v[192:195], a[8:11], v[52:55], v[28:31]
    ds_read_b128 v[52:55], v6 offset:64
    s_waitcnt lgkmcnt(1)
    v_mfma_f32_16x16x32_bf16 v[192:195], a[20:23], v[56:59], v[192:195]
    s_barrier
    v_mfma_f32_16x16x32_bf16 v[192:195], a[32:35], v[60:63], v[192:195]
    ds_read_b128 v[56:59], v6 offset:128
    v_mfma_f32_16x16x32_bf16 v[192:195], a[116:119], v[64:67], v[192:195]
    ds_read_b128 v[60:63], v4 offset:28800
    v_mfma_f32_16x16x32_bf16 v[192:195], a[128:131], v[168:171], v[192:195]
    ds_read_b128 v[64:67], v4 offset:28864
    v_mfma_f32_16x16x32_bf16 v[192:195], a[140:143], v[68:71], v[192:195]
    ds_read_b128 v[168:171], v4 offset:28928
    v_mfma_f32_16x16x32_bf16 v[192:195], a[224:227], v[72:75], v[192:195]
    ds_read_b128 v[68:71], v5 offset:28800
    v_mfma_f32_16x16x32_bf16 v[192:195], a[236:239], v[76:79], v[192:195]
    ds_read_b128 v[72:75], v5 offset:28864
    v_mfma_f32_16x16x32_bf16 v[192:195], a[248:251], v[172:175], v[192:195]
    ds_read_b128 v[76:79], v5 offset:28928
    v_mfma_f32_16x16x32_bf16 v[184:187], a[36:39], v[176:179], v[184:187]
    ds_read_b128 v[172:175], v6 offset:28800
    v_mfma_f32_16x16x32_bf16 v[184:187], a[48:51], v[180:183], v[184:187]
    ds_read_b128 v[148:151], v9 offset:0
    v_mfma_f32_16x16x32_bf16 v[184:187], a[60:63], v[32:35], v[184:187]
    ds_read_b128 v[152:155], v10 offset:0
    v_mfma_f32_16x16x32_bf16 v[184:187], a[144:147], v[36:39], v[184:187]
    ds_read_b128 v[156:159], v11 offset:0
    v_mfma_f32_16x16x32_bf16 v[184:187], a[156:159], v[40:43], v[184:187]
    ds_read_b128 v[160:163], v12 offset:0
    v_mfma_f32_16x16x32_bf16 v[184:187], a[168:171], v[44:47], v[184:187]
    ds_read_b128 v[164:167], v13 offset:0
    v_mfma_f32_16x16x32_bf16 v[184:187], a[252:255], v[48:51], v[184:187]
    s_waitcnt lgkmcnt(11)
    v_mfma_f32_16x16x32_bf16 v[184:187], v[88:91], v[52:55], v[184:187]
    s_mul_i32 s36, s29, 96
    v_mfma_f32_16x16x32_bf16 v[184:187], v[100:103], v[56:59], v[184:187]
    s_movk_i32 s38, 2731
    v_mfma_f32_16x16x32_bf16 v[188:191], a[40:43], v[176:179], v[188:191]
    s_mul_i32 s37, s30, 9216
    v_mfma_f32_16x16x32_bf16 v[188:191], a[52:55], v[180:183], v[188:191]
    v_add_u32 v18, s36, v0
    v_mfma_f32_16x16x32_bf16 v[188:191], a[64:67], v[32:35], v[188:191]
    s_add_u32 s43, s20, 294912
    v_mul_u32_u24 v9, s38, v18
    v_mfma_f32_16x16x32_bf16 v[188:191], a[148:151], v[36:39], v[188:191]
    s_waitcnt lgkmcnt(4)
    buffer_store_dwordx4 v[148:151], v19, s[24:27], s43 offen offset:0 sc0 sc1
    v_mfma_f32_16x16x32_bf16 v[188:191], a[160:163], v[40:43], v[188:191]
    v_mfma_f32_16x16x32_bf16 v[188:191], a[172:175], v[44:47], v[188:191]
    v_bfe_u32 v9, v9, 16, 2
    v_mfma_f32_16x16x32_bf16 v[188:191], v[80:83], v[48:51], v[188:191]
    v_xor_b32 v9, v9, v18
    v_mfma_f32_16x16x32_bf16 v[188:191], v[92:95], v[52:55], v[188:191]
    s_waitcnt lgkmcnt(1)
    buffer_store_dwordx4 v[152:155], v19, s[24:27], s43 offen offset:1024 sc0 sc1
    v_mfma_f32_16x16x32_bf16 v[188:191], v[104:107], v[56:59], v[188:191]
    v_mfma_f32_16x16x32_bf16 v[192:195], a[44:47], v[176:179], v[192:195]
    ds_read_b128 v[176:179], v6 offset:28864
    v_lshlrev_b32 v9, 4, v9
    v_mfma_f32_16x16x32_bf16 v[192:195], a[56:59], v[180:183], v[192:195]
    ds_read_b128 v[180:183], v6 offset:28928
    v_add_u32 v9, s37, v9
    v_mfma_f32_16x16x32_bf16 v[192:195], a[68:71], v[32:35], v[192:195]
    ds_read_b128 v[32:35], v4 offset:51072
    s_add_u32 s36, s36, 64
    v_mfma_f32_16x16x32_bf16 v[192:195], a[152:155], v[36:39], v[192:195]
    ds_read_b128 v[36:39], v4 offset:51136
    v_add_u32 v18, s36, v0
    v_mfma_f32_16x16x32_bf16 v[192:195], a[164:167], v[40:43], v[192:195]
    ds_read_b128 v[40:43], v4 offset:51200
    v_mul_u32_u24 v10, s38, v18
    v_mfma_f32_16x16x32_bf16 v[192:195], a[176:179], v[44:47], v[192:195]
    ds_read_b128 v[44:47], v5 offset:51072
    v_bfe_u32 v10, v10, 16, 2
    v_mfma_f32_16x16x32_bf16 v[192:195], v[84:87], v[48:51], v[192:195]
    ds_read_b128 v[48:51], v5 offset:51136
    v_xor_b32 v10, v10, v18
    v_mfma_f32_16x16x32_bf16 v[192:195], v[96:99], v[52:55], v[192:195]
    ds_read_b128 v[52:55], v5 offset:51200
    v_lshlrev_b32 v10, 4, v10
    v_mfma_f32_16x16x32_bf16 v[192:195], v[108:111], v[56:59], v[192:195]
    ds_read_b128 v[56:59], v6 offset:51072
    v_add_u32 v10, s37, v10
    v_mfma_f32_16x16x32_bf16 v[184:187], a[72:75], v[60:63], v[184:187]
    buffer_store_dwordx4 v[156:159], v19, s[24:27], s43 offen offset:2048 sc0 sc1
    v_mfma_f32_16x16x32_bf16 v[184:187], a[84:87], v[64:67], v[184:187]
    v_mfma_f32_16x16x32_bf16 v[184:187], a[96:99], v[168:171], v[184:187]
    v_mfma_f32_16x16x32_bf16 v[184:187], a[180:183], v[68:71], v[184:187]
    v_mfma_f32_16x16x32_bf16 v[184:187], a[192:195], v[72:75], v[184:187]
    buffer_store_dwordx4 v[160:163], v19, s[24:27], s43 offen offset:3072 sc0 sc1
    v_mfma_f32_16x16x32_bf16 v[184:187], a[204:207], v[76:79], v[184:187]
    v_mfma_f32_16x16x32_bf16 v[184:187], v[112:115], v[172:175], v[184:187]
    s_waitcnt lgkmcnt(5)
    v_mfma_f32_16x16x32_bf16 v[184:187], v[124:127], v[176:179], v[184:187]
    v_mfma_f32_16x16x32_bf16 v[184:187], v[136:139], v[180:183], v[184:187]
    s_mov_b32 exec_lo, 0
    buffer_store_dwordx4 v[164:167], v19, s[24:27], s43 offen offset:3584 sc0 sc1
    s_mov_b32 exec_lo, -1
    v_mfma_f32_16x16x32_bf16 v[188:191], a[76:79], v[60:63], v[188:191]
    v_mfma_f32_16x16x32_bf16 v[188:191], a[88:91], v[64:67], v[188:191]
    v_mfma_f32_16x16x32_bf16 v[188:191], a[100:103], v[168:171], v[188:191]
    v_mfma_f32_16x16x32_bf16 v[188:191], a[184:187], v[68:71], v[188:191]
    v_mfma_f32_16x16x32_bf16 v[188:191], a[196:199], v[72:75], v[188:191]
    v_mfma_f32_16x16x32_bf16 v[188:191], a[208:211], v[76:79], v[188:191]
    v_mfma_f32_16x16x32_bf16 v[188:191], v[116:119], v[172:175], v[188:191]
    v_mfma_f32_16x16x32_bf16 v[188:191], v[128:131], v[176:179], v[188:191]
    v_cvt_pk_bf16_f32 v184, v184, v185
    v_cvt_pk_bf16_f32 v185, v186, v187
    v_mfma_f32_16x16x32_bf16 v[188:191], v[140:143], v[180:183], v[188:191]
    ds_write_b32 v14, v184 offset:19200
    v_mfma_f32_16x16x32_bf16 v[192:195], a[80:83], v[60:63], v[192:195]
    ds_write_b32 v14, v185 offset:19204
    v_mfma_f32_16x16x32_bf16 v[192:195], a[92:95], v[64:67], v[192:195]
    ds_read_b128 v[60:63], v6 offset:51136
    v_mfma_f32_16x16x32_bf16 v[192:195], a[104:107], v[168:171], v[192:195]
    ds_read_b128 v[64:67], v6 offset:51200
    v_mfma_f32_16x16x32_bf16 v[192:195], a[188:191], v[68:71], v[192:195]
    ds_read_b128 v[168:171], v4 offset:3072
    v_mfma_f32_16x16x32_bf16 v[192:195], a[200:203], v[72:75], v[192:195]
    ds_read_b128 v[68:71], v4 offset:3136
    v_mfma_f32_16x16x32_bf16 v[192:195], a[212:215], v[76:79], v[192:195]
    ds_read_b128 v[72:75], v4 offset:3200
    v_mfma_f32_16x16x32_bf16 v[192:195], v[120:123], v[172:175], v[192:195]
    ds_read_b128 v[76:79], v5 offset:3072
    v_mfma_f32_16x16x32_bf16 v[192:195], v[132:135], v[176:179], v[192:195]
    v_cvt_pk_bf16_f32 v188, v188, v189
    v_cvt_pk_bf16_f32 v189, v190, v191
    v_mfma_f32_16x16x32_bf16 v[192:195], v[144:147], v[180:183], v[192:195]
    ds_write_b32 v15, v188 offset:19200
    v_mfma_f32_16x16x32_bf16 v[196:199], a[0:3], v[32:35], v[20:23]
    ds_write_b32 v15, v189 offset:19204
    v_mfma_f32_16x16x32_bf16 v[196:199], a[12:15], v[36:39], v[196:199]
    ds_read_b128 v[172:175], v5 offset:3136
    s_waitcnt lgkmcnt(11)
    v_mfma_f32_16x16x32_bf16 v[196:199], a[24:27], v[40:43], v[196:199]
    ds_read_b128 v[176:179], v5 offset:3200
    v_mfma_f32_16x16x32_bf16 v[196:199], a[108:111], v[44:47], v[196:199]
    ds_read_b128 v[180:183], v6 offset:3072
    v_mfma_f32_16x16x32_bf16 v[196:199], a[120:123], v[48:51], v[196:199]
    v_mfma_f32_16x16x32_bf16 v[196:199], a[132:135], v[52:55], v[196:199]
    v_mfma_f32_16x16x32_bf16 v[196:199], a[216:219], v[56:59], v[196:199]
    s_waitcnt lgkmcnt(8)
    v_mfma_f32_16x16x32_bf16 v[196:199], a[228:231], v[60:63], v[196:199]
    v_cvt_pk_bf16_f32 v192, v192, v193
    v_cvt_pk_bf16_f32 v193, v194, v195
    v_mfma_f32_16x16x32_bf16 v[196:199], a[240:243], v[64:67], v[196:199]
    ds_write_b32 v14, v192 offset:19264
    v_mfma_f32_16x16x32_bf16 v[200:203], a[4:7], v[32:35], v[24:27]
    ds_write_b32 v14, v193 offset:19268
    v_mfma_f32_16x16x32_bf16 v[200:203], a[16:19], v[36:39], v[200:203]
    v_mfma_f32_16x16x32_bf16 v[200:203], a[28:31], v[40:43], v[200:203]
    v_mfma_f32_16x16x32_bf16 v[200:203], a[112:115], v[44:47], v[200:203]
    v_mfma_f32_16x16x32_bf16 v[200:203], a[124:127], v[48:51], v[200:203]
    v_mfma_f32_16x16x32_bf16 v[200:203], a[136:139], v[52:55], v[200:203]
    v_mfma_f32_16x16x32_bf16 v[200:203], a[220:223], v[56:59], v[200:203]
    v_mfma_f32_16x16x32_bf16 v[200:203], a[232:235], v[60:63], v[200:203]
    s_waitcnt lgkmcnt(0)
    v_mfma_f32_16x16x32_bf16 v[200:203], a[244:247], v[64:67], v[200:203]
    s_barrier
    v_mfma_f32_16x16x32_bf16 v[204:207], a[8:11], v[32:35], v[28:31]
    ds_read_b128 v[32:35], v6 offset:3136
    v_mfma_f32_16x16x32_bf16 v[204:207], a[20:23], v[36:39], v[204:207]
    ds_read_b128 v[36:39], v6 offset:3200
    v_mfma_f32_16x16x32_bf16 v[204:207], a[32:35], v[40:43], v[204:207]
    ds_read_b128 v[40:43], v4 offset:31872
    v_mfma_f32_16x16x32_bf16 v[204:207], a[116:119], v[44:47], v[204:207]
    ds_read_b128 v[44:47], v4 offset:31936
    v_mfma_f32_16x16x32_bf16 v[204:207], a[128:131], v[48:51], v[204:207]
    ds_read_b128 v[48:51], v4 offset:32000
    v_mfma_f32_16x16x32_bf16 v[204:207], a[140:143], v[52:55], v[204:207]
    ds_read_b128 v[52:55], v5 offset:31872
    v_mfma_f32_16x16x32_bf16 v[204:207], a[224:227], v[56:59], v[204:207]
    ds_read_b128 v[56:59], v5 offset:31936
    v_mfma_f32_16x16x32_bf16 v[204:207], a[236:239], v[60:63], v[204:207]
    ds_read_b128 v[60:63], v5 offset:32000
    v_mfma_f32_16x16x32_bf16 v[204:207], a[248:251], v[64:67], v[204:207]
    ds_read_b128 v[64:67], v6 offset:31872
    v_mfma_f32_16x16x32_bf16 v[196:199], a[36:39], v[168:171], v[196:199]
    ds_read_b128 v[148:151], v9 offset:19200
    v_mfma_f32_16x16x32_bf16 v[196:199], a[48:51], v[68:71], v[196:199]
    ds_read_b128 v[152:155], v10 offset:19200
    v_mfma_f32_16x16x32_bf16 v[196:199], a[60:63], v[72:75], v[196:199]
    v_mfma_f32_16x16x32_bf16 v[196:199], a[144:147], v[76:79], v[196:199]
    v_mfma_f32_16x16x32_bf16 v[196:199], a[156:159], v[172:175], v[196:199]
    v_mfma_f32_16x16x32_bf16 v[196:199], a[168:171], v[176:179], v[196:199]
    v_mfma_f32_16x16x32_bf16 v[196:199], a[252:255], v[180:183], v[196:199]
    s_waitcnt lgkmcnt(7)
    v_mfma_f32_16x16x32_bf16 v[196:199], v[88:91], v[32:35], v[196:199]
    v_mfma_f32_16x16x32_bf16 v[196:199], v[100:103], v[36:39], v[196:199]
    v_mfma_f32_16x16x32_bf16 v[200:203], a[40:43], v[168:171], v[200:203]
    s_add_u32 s43, s22, 368640
    v_mfma_f32_16x16x32_bf16 v[200:203], a[52:55], v[68:71], v[200:203]
    s_waitcnt lgkmcnt(1)
    buffer_store_dwordx4 v[148:151], v19, s[24:27], s43 offen sc0 sc1
    v_mfma_f32_16x16x32_bf16 v[200:203], a[64:67], v[72:75], v[200:203]
    v_mfma_f32_16x16x32_bf16 v[200:203], a[148:151], v[76:79], v[200:203]
    v_mfma_f32_16x16x32_bf16 v[200:203], a[160:163], v[172:175], v[200:203]
    v_mfma_f32_16x16x32_bf16 v[200:203], a[172:175], v[176:179], v[200:203]
    v_mfma_f32_16x16x32_bf16 v[200:203], v[80:83], v[180:183], v[200:203]
    v_mfma_f32_16x16x32_bf16 v[200:203], v[92:95], v[32:35], v[200:203]
    v_mfma_f32_16x16x32_bf16 v[200:203], v[104:107], v[36:39], v[200:203]
    v_mfma_f32_16x16x32_bf16 v[204:207], a[44:47], v[168:171], v[204:207]
    ds_read_b128 v[168:171], v6 offset:31936
    v_mfma_f32_16x16x32_bf16 v[204:207], a[56:59], v[68:71], v[204:207]
    ds_read_b128 v[68:71], v6 offset:32000
    v_mfma_f32_16x16x32_bf16 v[204:207], a[68:71], v[72:75], v[204:207]
    ds_read_b128 v[72:75], v4 offset:54144
    v_mfma_f32_16x16x32_bf16 v[204:207], a[152:155], v[76:79], v[204:207]
    ds_read_b128 v[76:79], v4 offset:54208
    v_mfma_f32_16x16x32_bf16 v[204:207], a[164:167], v[172:175], v[204:207]
    ds_read_b128 v[172:175], v4 offset:54272
    v_mfma_f32_16x16x32_bf16 v[204:207], a[176:179], v[176:179], v[204:207]
    ds_read_b128 v[176:179], v5 offset:54144
    v_mfma_f32_16x16x32_bf16 v[204:207], v[84:87], v[180:183], v[204:207]
    ds_read_b128 v[180:183], v5 offset:54208
    v_mfma_f32_16x16x32_bf16 v[204:207], v[96:99], v[32:35], v[204:207]
    ds_read_b128 v[32:35], v5 offset:54272
    v_mfma_f32_16x16x32_bf16 v[204:207], v[108:111], v[36:39], v[204:207]
    ds_read_b128 v[36:39], v6 offset:54144
    v_mfma_f32_16x16x32_bf16 v[196:199], a[72:75], v[40:43], v[196:199]
    v_mfma_f32_16x16x32_bf16 v[196:199], a[84:87], v[44:47], v[196:199]
    v_mfma_f32_16x16x32_bf16 v[196:199], a[96:99], v[48:51], v[196:199]
    v_mfma_f32_16x16x32_bf16 v[196:199], a[180:183], v[52:55], v[196:199]
    v_mfma_f32_16x16x32_bf16 v[196:199], a[192:195], v[56:59], v[196:199]
    v_mfma_f32_16x16x32_bf16 v[196:199], a[204:207], v[60:63], v[196:199]
    v_mfma_f32_16x16x32_bf16 v[196:199], v[112:115], v[64:67], v[196:199]
    s_waitcnt lgkmcnt(5)
    v_mfma_f32_16x16x32_bf16 v[196:199], v[124:127], v[168:171], v[196:199]
    v_mfma_f32_16x16x32_bf16 v[196:199], v[136:139], v[68:71], v[196:199]
    s_mov_b32 exec_hi, 0
    buffer_store_dwordx4 v[152:155], v19, s[24:27], s43 offen offset:1024 sc0 sc1
    s_mov_b32 exec_hi, -1
    v_mfma_f32_16x16x32_bf16 v[200:203], a[76:79], v[40:43], v[200:203]
    v_mfma_f32_16x16x32_bf16 v[200:203], a[88:91], v[44:47], v[200:203]
    v_mfma_f32_16x16x32_bf16 v[200:203], a[100:103], v[48:51], v[200:203]
    v_mfma_f32_16x16x32_bf16 v[200:203], a[184:187], v[52:55], v[200:203]
    v_mfma_f32_16x16x32_bf16 v[200:203], a[196:199], v[56:59], v[200:203]
    v_mfma_f32_16x16x32_bf16 v[200:203], a[208:211], v[60:63], v[200:203]
    v_mfma_f32_16x16x32_bf16 v[200:203], v[116:119], v[64:67], v[200:203]
    v_mfma_f32_16x16x32_bf16 v[200:203], v[128:131], v[168:171], v[200:203]
    v_cvt_pk_bf16_f32 v196, v196, v197
    v_cvt_pk_bf16_f32 v197, v198, v199
    v_mfma_f32_16x16x32_bf16 v[200:203], v[140:143], v[68:71], v[200:203]
    ds_write_b32 v14, v196 offset:22272
    v_mfma_f32_16x16x32_bf16 v[204:207], a[80:83], v[40:43], v[204:207]
    ds_write_b32 v14, v197 offset:22276
    v_mfma_f32_16x16x32_bf16 v[204:207], a[92:95], v[44:47], v[204:207]
    ds_read_b128 v[40:43], v6 offset:54208
    v_mfma_f32_16x16x32_bf16 v[204:207], a[104:107], v[48:51], v[204:207]
    ds_read_b128 v[44:47], v6 offset:54272
    v_mfma_f32_16x16x32_bf16 v[204:207], a[188:191], v[52:55], v[204:207]
    ds_read_b128 v[48:51], v4 offset:6144
    v_mfma_f32_16x16x32_bf16 v[204:207], a[200:203], v[56:59], v[204:207]
    ds_read_b128 v[52:55], v4 offset:6208
    v_mfma_f32_16x16x32_bf16 v[204:207], a[212:215], v[60:63], v[204:207]
    ds_read_b128 v[56:59], v4 offset:6272
    v_mfma_f32_16x16x32_bf16 v[204:207], v[120:123], v[64:67], v[204:207]
    ds_read_b128 v[60:63], v5 offset:6144
    v_mfma_f32_16x16x32_bf16 v[204:207], v[132:135], v[168:171], v[204:207]
    v_cvt_pk_bf16_f32 v200, v200, v201
    v_cvt_pk_bf16_f32 v201, v202, v203
    v_mfma_f32_16x16x32_bf16 v[204:207], v[144:147], v[68:71], v[204:207]
    ds_write_b32 v15, v200 offset:22272
    v_mfma_f32_16x16x32_bf16 v[208:211], a[0:3], v[72:75], v[20:23]
    ds_write_b32 v15, v201 offset:22276
    v_mfma_f32_16x16x32_bf16 v[208:211], a[12:15], v[76:79], v[208:211]
    ds_read_b128 v[64:67], v5 offset:6208
    s_waitcnt lgkmcnt(11)
    v_mfma_f32_16x16x32_bf16 v[208:211], a[24:27], v[172:175], v[208:211]
    ds_read_b128 v[168:171], v5 offset:6272
    v_mfma_f32_16x16x32_bf16 v[208:211], a[108:111], v[176:179], v[208:211]
    ds_read_b128 v[68:71], v6 offset:6144
    v_mfma_f32_16x16x32_bf16 v[208:211], a[120:123], v[180:183], v[208:211]
    v_mfma_f32_16x16x32_bf16 v[208:211], a[132:135], v[32:35], v[208:211]
    v_mfma_f32_16x16x32_bf16 v[208:211], a[216:219], v[36:39], v[208:211]
    s_waitcnt lgkmcnt(8)
    v_mfma_f32_16x16x32_bf16 v[208:211], a[228:231], v[40:43], v[208:211]
    v_cvt_pk_bf16_f32 v204, v204, v205
    v_cvt_pk_bf16_f32 v205, v206, v207
    v_mfma_f32_16x16x32_bf16 v[208:211], a[240:243], v[44:47], v[208:211]
    ds_write_b32 v14, v204 offset:22336
    v_mfma_f32_16x16x32_bf16 v[212:215], a[4:7], v[72:75], v[24:27]
    ds_write_b32 v14, v205 offset:22340
    v_mfma_f32_16x16x32_bf16 v[212:215], a[16:19], v[76:79], v[212:215]
    v_mfma_f32_16x16x32_bf16 v[212:215], a[28:31], v[172:175], v[212:215]
    v_mfma_f32_16x16x32_bf16 v[212:215], a[112:115], v[176:179], v[212:215]
    v_mfma_f32_16x16x32_bf16 v[212:215], a[124:127], v[180:183], v[212:215]
    v_mfma_f32_16x16x32_bf16 v[212:215], a[136:139], v[32:35], v[212:215]
    v_mfma_f32_16x16x32_bf16 v[212:215], a[220:223], v[36:39], v[212:215]
    v_mfma_f32_16x16x32_bf16 v[212:215], a[232:235], v[40:43], v[212:215]
    s_waitcnt lgkmcnt(0)
    v_mfma_f32_16x16x32_bf16 v[212:215], a[244:247], v[44:47], v[212:215]
    s_barrier
    v_mfma_f32_16x16x32_bf16 v[216:219], a[8:11], v[72:75], v[28:31]
    ds_read_b128 v[72:75], v6 offset:6208
    v_mfma_f32_16x16x32_bf16 v[216:219], a[20:23], v[76:79], v[216:219]
    ds_read_b128 v[76:79], v6 offset:6272
    v_mfma_f32_16x16x32_bf16 v[216:219], a[32:35], v[172:175], v[216:219]
    ds_read_b128 v[172:175], v4 offset:34944
    v_mfma_f32_16x16x32_bf16 v[216:219], a[116:119], v[176:179], v[216:219]
    ds_read_b128 v[176:179], v4 offset:35008
    v_mfma_f32_16x16x32_bf16 v[216:219], a[128:131], v[180:183], v[216:219]
    ds_read_b128 v[180:183], v4 offset:35072
    v_mfma_f32_16x16x32_bf16 v[216:219], a[140:143], v[32:35], v[216:219]
    ds_read_b128 v[32:35], v5 offset:34944
    v_mfma_f32_16x16x32_bf16 v[216:219], a[224:227], v[36:39], v[216:219]
    ds_read_b128 v[36:39], v5 offset:35008
    v_mfma_f32_16x16x32_bf16 v[216:219], a[236:239], v[40:43], v[216:219]
    ds_read_b128 v[40:43], v5 offset:35072
    v_mfma_f32_16x16x32_bf16 v[216:219], a[248:251], v[44:47], v[216:219]
    ds_read_b128 v[44:47], v6 offset:34944
    v_mfma_f32_16x16x32_bf16 v[208:211], a[36:39], v[48:51], v[208:211]
    ds_read_b128 v[148:151], v9 offset:22272
    v_mfma_f32_16x16x32_bf16 v[208:211], a[48:51], v[52:55], v[208:211]
    ds_read_b128 v[152:155], v10 offset:22272
    v_mfma_f32_16x16x32_bf16 v[208:211], a[60:63], v[56:59], v[208:211]
    v_mfma_f32_16x16x32_bf16 v[208:211], a[144:147], v[60:63], v[208:211]
    v_mfma_f32_16x16x32_bf16 v[208:211], a[156:159], v[64:67], v[208:211]
    v_mfma_f32_16x16x32_bf16 v[208:211], a[168:171], v[168:171], v[208:211]
    v_mfma_f32_16x16x32_bf16 v[208:211], a[252:255], v[68:71], v[208:211]
    s_waitcnt lgkmcnt(7)
    v_mfma_f32_16x16x32_bf16 v[208:211], v[88:91], v[72:75], v[208:211]
    v_mfma_f32_16x16x32_bf16 v[208:211], v[100:103], v[76:79], v[208:211]
    v_mfma_f32_16x16x32_bf16 v[212:215], a[40:43], v[48:51], v[212:215]
    s_add_u32 s43, s22, 371712
    v_mfma_f32_16x16x32_bf16 v[212:215], a[52:55], v[52:55], v[212:215]
    s_waitcnt lgkmcnt(1)
    buffer_store_dwordx4 v[148:151], v19, s[24:27], s43 offen sc0 sc1
    v_mfma_f32_16x16x32_bf16 v[212:215], a[64:67], v[56:59], v[212:215]
    v_mfma_f32_16x16x32_bf16 v[212:215], a[148:151], v[60:63], v[212:215]
    v_mfma_f32_16x16x32_bf16 v[212:215], a[160:163], v[64:67], v[212:215]
    v_mfma_f32_16x16x32_bf16 v[212:215], a[172:175], v[168:171], v[212:215]
    v_mfma_f32_16x16x32_bf16 v[212:215], v[80:83], v[68:71], v[212:215]
    v_mfma_f32_16x16x32_bf16 v[212:215], v[92:95], v[72:75], v[212:215]
    v_mfma_f32_16x16x32_bf16 v[212:215], v[104:107], v[76:79], v[212:215]
    v_mfma_f32_16x16x32_bf16 v[216:219], a[44:47], v[48:51], v[216:219]
    ds_read_b128 v[48:51], v6 offset:35008
    v_mfma_f32_16x16x32_bf16 v[216:219], a[56:59], v[52:55], v[216:219]
    ds_read_b128 v[52:55], v6 offset:35072
    v_mfma_f32_16x16x32_bf16 v[216:219], a[68:71], v[56:59], v[216:219]
    v_mfma_f32_16x16x32_bf16 v[216:219], a[152:155], v[60:63], v[216:219]
    v_mfma_f32_16x16x32_bf16 v[216:219], a[164:167], v[64:67], v[216:219]
    v_mfma_f32_16x16x32_bf16 v[216:219], a[176:179], v[168:171], v[216:219]
    v_mfma_f32_16x16x32_bf16 v[216:219], v[84:87], v[68:71], v[216:219]
    v_mfma_f32_16x16x32_bf16 v[216:219], v[96:99], v[72:75], v[216:219]
    v_mfma_f32_16x16x32_bf16 v[216:219], v[108:111], v[76:79], v[216:219]
    v_mfma_f32_16x16x32_bf16 v[208:211], a[72:75], v[172:175], v[208:211]
    v_mfma_f32_16x16x32_bf16 v[208:211], a[84:87], v[176:179], v[208:211]
    v_mfma_f32_16x16x32_bf16 v[208:211], a[96:99], v[180:183], v[208:211]
    v_mfma_f32_16x16x32_bf16 v[208:211], a[180:183], v[32:35], v[208:211]
    v_mfma_f32_16x16x32_bf16 v[208:211], a[192:195], v[36:39], v[208:211]
    v_mfma_f32_16x16x32_bf16 v[208:211], a[204:207], v[40:43], v[208:211]
    v_mfma_f32_16x16x32_bf16 v[208:211], v[112:115], v[44:47], v[208:211]
    s_waitcnt lgkmcnt(0)
    v_mfma_f32_16x16x32_bf16 v[208:211], v[124:127], v[48:51], v[208:211]
    v_mfma_f32_16x16x32_bf16 v[208:211], v[136:139], v[52:55], v[208:211]
    s_mov_b32 exec_hi, 0
    buffer_store_dwordx4 v[152:155], v19, s[24:27], s43 offen offset:1024 sc0 sc1
    s_mov_b32 exec_hi, -1
    v_mfma_f32_16x16x32_bf16 v[212:215], a[76:79], v[172:175], v[212:215]
    v_mfma_f32_16x16x32_bf16 v[212:215], a[88:91], v[176:179], v[212:215]
    v_mfma_f32_16x16x32_bf16 v[212:215], a[100:103], v[180:183], v[212:215]
    v_mfma_f32_16x16x32_bf16 v[212:215], a[184:187], v[32:35], v[212:215]
    v_mfma_f32_16x16x32_bf16 v[212:215], a[196:199], v[36:39], v[212:215]
    v_mfma_f32_16x16x32_bf16 v[212:215], a[208:211], v[40:43], v[212:215]
    v_mfma_f32_16x16x32_bf16 v[212:215], v[116:119], v[44:47], v[212:215]
    v_mfma_f32_16x16x32_bf16 v[212:215], v[128:131], v[48:51], v[212:215]
    v_cvt_pk_bf16_f32 v208, v208, v209
    v_cvt_pk_bf16_f32 v209, v210, v211
    v_mfma_f32_16x16x32_bf16 v[212:215], v[140:143], v[52:55], v[212:215]
    ds_write_b32 v14, v208 offset:25344
    v_mfma_f32_16x16x32_bf16 v[216:219], a[80:83], v[172:175], v[216:219]
    ds_write_b32 v14, v209 offset:25348
    v_mfma_f32_16x16x32_bf16 v[216:219], a[92:95], v[176:179], v[216:219]
    v_mfma_f32_16x16x32_bf16 v[216:219], a[104:107], v[180:183], v[216:219]
    v_mfma_f32_16x16x32_bf16 v[216:219], a[188:191], v[32:35], v[216:219]
    v_mfma_f32_16x16x32_bf16 v[216:219], a[200:203], v[36:39], v[216:219]
    v_mfma_f32_16x16x32_bf16 v[216:219], a[212:215], v[40:43], v[216:219]
    v_mfma_f32_16x16x32_bf16 v[216:219], v[120:123], v[44:47], v[216:219]
    v_mfma_f32_16x16x32_bf16 v[216:219], v[132:135], v[48:51], v[216:219]
    v_mfma_f32_16x16x32_bf16 v[216:219], v[144:147], v[52:55], v[216:219]
    v_cvt_pk_bf16_f32 v212, v212, v213
    v_cvt_pk_bf16_f32 v213, v214, v215
    ds_write_b64 v15, v[212:213] offset:25344
    s_nop 4
    v_cvt_pk_bf16_f32 v216, v216, v217
    v_cvt_pk_bf16_f32 v217, v218, v219
    ds_write_b64 v14, v[216:217] offset:25408
    s_waitcnt lgkmcnt(0)
    s_barrier
    ds_read_b128 v[156:159], v9 offset:25344
    ds_read_b128 v[160:163], v10 offset:25344
    s_add_u32 s43, s22, 374784
    s_waitcnt lgkmcnt(1)
    buffer_store_dwordx4 v[156:159], v19, s[24:27], s43 offen sc0 sc1
    s_waitcnt lgkmcnt(0)
    s_mov_b32 exec_hi, 0
    buffer_store_dwordx4 v[160:163], v19, s[24:27], s43 offen offset:1024 sc0 sc1
    s_mov_b32 exec_hi, -1
L_end:
    s_endpgm
.section .rodata,"a"
.p2align 6
.amdhsa_kernel standalone__standard_2d_1d_3d_conv__vision_kernel
  .amdhsa_next_free_vgpr 512
  .amdhsa_next_free_sgpr 102
  .amdhsa_accum_offset 256
  .amdhsa_group_segment_fixed_size 0
  .amdhsa_kernarg_size 48
  .amdhsa_float_denorm_mode_32 3
  .amdhsa_user_sgpr_count 2
  .amdhsa_user_sgpr_kernarg_segment_ptr 1
  .amdhsa_system_sgpr_workgroup_id_x 1
.end_amdhsa_kernel
```
